```python
import torch

def _softmax(x, axis=-1):
    return torch.softmax(x, dim=axis)
def _gelu(x):
    return torch.nn.functional.gelu(x, approximate="tanh")
def _silu(x):
    return torch.nn.functional.silu(x)
def _sigmoid(x):
    return torch.sigmoid(x)
def _layernorm(x, axis=-1, eps=1e-5):
    m = x.mean(dim=axis, keepdim=True)
    v = x.var(dim=axis, keepdim=True, unbiased=False)
    return (x - m) / torch.sqrt(v + eps)
def _scatter_add(tgt, idx, src, axis=0):
    return tgt.clone().index_add_(axis, idx, src)
def _segment_sum(src, seg, n):
    out = torch.zeros((n,) + src.shape[1:], dtype=src.dtype)
    return out.index_add_(0, seg, src)
def _pad(x, pw):
    flat = tuple(v for pair in reversed(pw) for v in pair)
    return torch.nn.functional.pad(x, flat)

kernel_name = 'standalone__gqa_softmax__near_ridge'

def setup_inputs():

    _w = (lambda a: (lambda t: t.to(torch.bfloat16) if t.is_floating_point() else t)(torch.as_tensor(a)))
    B, Hq, Hkv, Sq, Sk, D = 8, 16, 8, 96, 1024, 256
    return {
        "q": _w((lambda *s: torch.randn(*s, dtype=torch.bfloat16) * 0.8)(B, Hq, Sq, D)),
        "k": _w((lambda *s: torch.randn(*s, dtype=torch.bfloat16) * 0.8)(B, Hkv, Sk, D)),
        "v": _w((lambda *s: torch.randn(*s, dtype=torch.bfloat16) * 0.05)(B, Hkv, Sk, D)),
    }

def reference(q, k, v):
    B, Hq, Sq, D = q.shape
    Hkv = k.shape[1]
    rep = Hq // Hkv
    k = (lambda x, n, axis: torch.repeat_interleave(x, n, dim=axis))(k, rep, axis=1)
    v = (lambda x, n, axis: torch.repeat_interleave(x, n, dim=axis))(v, rep, axis=1)
    scale = D ** -0.5
    scores = torch.einsum("bhqd,bhkd->bhqk", q, k) * scale
    p = _softmax(scores, axis=-1)
    return torch.einsum("bhqk,bhkd->bhqd", p, v)
```

```asm
; @launch grid=(256,1,1) block=(256,1,1) lds=163840
.amdgcn_target "amdgcn-amd-amdhsa--gfx950"
.text
.globl standalone__gqa_softmax__near_ridge_kernel
.p2align 8
.type standalone__gqa_softmax__near_ridge_kernel,@function
standalone__gqa_softmax__near_ridge_kernel:
    s_cmp_ge_u32 s2, 256
    s_cbranch_scc1 L_end
    s_load_dwordx8 s[4:11], s[0:1], 0
    s_load_dwordx2 s[52:53], s[0:1], 40
    v_lshrrev_b32 v1, 6, v0
    v_and_b32 v63, 63, v0
    s_getpc_b64 s[80:81]
    v_min_u32 v48, 3, v63
    v_mad_u32_u24 v48, v1, 4, v48
    s_lshr_b32 s56, s2, 3
    v_lshl_add_u32 v51, s56, 2, v1
    v_min_u32 v52, 5, v63
    v_mad_u32_u24 v51, v51, 2, v52
    v_add_u32 v51, 12, v51
    v_min_u32 v51, 159, v51
    v_cmp_gt_u32 vcc, 4, v63
    s_nop 1
    v_cndmask_b32 v48, v51, v48, vcc
    v_lshlrev_b32 v48, 7, v48
    v_mov_b32 v49, s81
    v_add_co_u32 v48, vcc, s80, v48
    s_nop 1
    v_addc_co_u32 v49, vcc, 0, v49, vcc
    global_load_dword v50, v[48:49], off
    v_readfirstlane_b32 s32, v1
    v_lshrrev_b32 v62, 5, v63
    v_and_b32 v61, 31, v63
    v_xor_b32 v61, v61, v62
    v_lshlrev_b32 v61, 4, v61
    v_lshl_add_u32 v61, v62, 9, v61
    s_and_b32 s54, s2, 7
    s_lshl_b32 s54, s54, 3
    s_lshr_b32 s55, s2, 5
    s_add_u32 s54, s54, s55
    s_bfe_u32 s55, s2, 0x20003
    s_and_b32 s56, s55, 1
    s_lshr_b32 s57, s55, 1
    s_and_b32 s49, s32, 1
    s_lshr_b32 s50, s32, 1
    s_lshl_b32 s47, s50, 7
    v_xor_b32 v16, s47, v61
    v_xor_b32 v17, 32, v16
    v_xor_b32 v18, 64, v16
    v_xor_b32 v19, 96, v16
    s_mul_i32 s39, s54, 192
    s_mul_i32 s47, s56, 96
    s_add_u32 s39, s39, s47
    s_lshl_b32 s39, s39, 9
    s_lshl_b32 s58, s50, 12
    s_mul_i32 s47, s49, 24576
    s_add_u32 s47, s47, s58
    s_add_u32 s84, s47, 98304
    s_add_u32 s85, s47, s39
    s_waitcnt lgkmcnt(0)
    s_mov_b32 s12, s4
    s_mov_b32 s13, s5
    s_mov_b32 s14, 0x600000
    s_mov_b32 s15, 0x20000
    s_add_u32 m0, s84, 0
    s_add_u32 s37, s85, 0
    buffer_load_dwordx4 v16, s[12:15], s37 offen offset:0 nt lds
    buffer_load_dwordx4 v17, s[12:15], s37 offen offset:1024 nt lds
    buffer_load_dwordx4 v18, s[12:15], s37 offen offset:2048 nt lds
    buffer_load_dwordx4 v19, s[12:15], s37 offen offset:3072 nt lds
    s_add_u32 m0, s84, 8192
    s_add_u32 s37, s85, 8192
    buffer_load_dwordx4 v16, s[12:15], s37 offen offset:0 nt lds
    buffer_load_dwordx4 v17, s[12:15], s37 offen offset:1024 nt lds
    buffer_load_dwordx4 v18, s[12:15], s37 offen offset:2048 nt lds
    buffer_load_dwordx4 v19, s[12:15], s37 offen offset:3072 nt lds
    s_mov_b32 s28, s52
    s_mov_b32 s29, s53
    s_mov_b32 s30, 0x10000000
    s_mov_b32 s31, 0x20000
    s_mov_b32 s16, s6
    s_mov_b32 s17, s7
    s_mov_b32 s18, 0x2000000
    s_mov_b32 s19, 0x20000
    s_mov_b32 s20, s8
    s_mov_b32 s21, s9
    s_mov_b32 s22, 0x2000000
    s_mov_b32 s23, 0x20000
    s_mov_b32 s24, s10
    s_mov_b32 s25, s11
    s_mov_b32 s26, 0x600000
    s_mov_b32 s27, 0x20000
    s_lshl_b32 s59, s54, 19
    s_lshl_b32 s47, s57, 18
    s_add_u32 s59, s59, s47
    s_lshl_b32 s47, s49, 17
    s_add_u32 s59, s59, s47
    s_lshl_b32 s47, s50, 16
    s_add_u32 s34, s59, s47
    s_mul_i32 s33, s49, 49152
    s_add_u32 s33, s33, s58
    s_lshl_b32 s40, s2, 2
    s_add_u32 s40, s40, s32
    s_lshl_b32 s40, s40, 9
    s_xor_b32 s41, s40, 32768
    s_lshl_b32 s47, s50, 13
    s_add_u32 s55, s59, s47
    s_lshl_b32 s48, s49, 7
    s_add_u32 s55, s55, s48
    s_lshl_b32 s47, s57, 8
    s_add_u32 s55, s55, s47
    s_xor_b32 s52, s55, 384
    s_xor_b32 s53, s55, 256
    s_xor_b32 s54, s55, 128
    s_mul_i32 s45, s50, 24576
    s_add_u32 s45, s45, s39
    s_add_u32 s45, s45, s47
    s_lshl_b32 s47, s49, 7
    s_add_u32 s45, s45, s47
    s_xor_b32 s44, s45, 256
    s_mov_b32 s38, 0x3db8aa3b
    v_and_b32 v60, 15, v63
    v_lshrrev_b32 v59, 4, v63
    v_xor_b32 v58, v59, v60
    v_lshlrev_b32 v58, 4, v58
    v_lshl_add_u32 v58, v60, 9, v58
    s_mul_i32 s47, s49, 49152
    s_mul_i32 s48, s50, 24576
    s_add_u32 s48, s48, 98304
    v_xor_b32 v57, 0, v58
    v_add_u32 v20, s47, v57
    v_add_u32 v24, s48, v57
    v_xor_b32 v57, 64, v58
    v_add_u32 v21, s47, v57
    v_add_u32 v25, s48, v57
    v_xor_b32 v57, 128, v58
    v_add_u32 v22, s47, v57
    v_add_u32 v26, s48, v57
    v_xor_b32 v57, 192, v58
    v_add_u32 v23, s47, v57
    v_add_u32 v27, s48, v57
    s_sub_u32 s80, s48, s47
    v_lshrrev_b32 v58, 3, v63
    v_and_b32 v57, 6, v58
    v_xor_b32 v57, v57, v63
    v_and_b32 v57, 7, v57
    v_lshlrev_b32 v57, 4, v57
    v_lshl_add_u32 v6, v58, 9, v57
    s_mul_i32 s51, s49, 24576
    s_add_u32 s51, s51, 98304
    v_lshrrev_b32 v58, 2, v63
    v_bfe_u32 v57, v63, 3, 2
    v_lshlrev_b32 v57, 5, v57
    v_lshl_add_u32 v57, v58, 7, v57
    v_and_b32 v58, 3, v63
    v_lshl_add_u32 v57, v58, 3, v57
    v_xor_b32 v58, 0, v57
    v_add_u32 v8, s47, v58
    v_add_u32 v44, s51, v58
    v_xor_b32 v58, 32, v57
    v_add_u32 v9, s47, v58
    v_add_u32 v45, s51, v58
    v_xor_b32 v58, 64, v57
    v_add_u32 v10, s47, v58
    v_add_u32 v46, s51, v58
    v_xor_b32 v58, 96, v57
    v_add_u32 v11, s47, v58
    v_add_u32 v47, s51, v58
    s_sub_u32 s81, s51, s47
    s_add_u32 s51, s51, s58
    v_lshlrev_b32 v58, 4, v63
    s_xor_b32 s48, s32, 1
    s_mul_i32 s47, s32, 12288
    s_add_u32 s47, s47, 98304
    v_add_u32 v0, s47, v58
    s_mul_i32 s47, s48, 12288
    s_add_u32 s47, s47, 98304
    v_add_u32 v1, s47, v58
    s_lshl_b32 s47, s32, 11
    s_add_u32 s47, s47, 147456
    v_add_u32 v7, s47, v58
    s_lshl_b32 s47, s48, 11
    s_add_u32 s47, s47, 147456
    v_add_u32 v15, s47, v58
    v_mov_b32 v58, 0x3f803f80
    v_accvgpr_write_b32 a160, v58
    v_accvgpr_write_b32 a161, v58
    v_accvgpr_write_b32 a162, v58
    v_accvgpr_write_b32 a163, v58
    v_accvgpr_write_b32 a164, v16
    v_accvgpr_write_b32 a165, v17
    v_accvgpr_write_b32 a166, v18
    v_accvgpr_write_b32 a167, v19
    v_accvgpr_write_b32 a168, v20
    v_accvgpr_write_b32 a169, v21
    v_accvgpr_write_b32 a170, v22
    v_accvgpr_write_b32 a171, v23
    v_mov_b32 v58, 0xff800000
    v_accvgpr_write_b32 a172, v58
    v_accvgpr_write_b32 a173, v58
    v_accvgpr_write_b32 a174, v58
    s_mov_b32 s82, 0
    s_mov_b32 s93, 0
    s_mov_b32 s42, 0
    s_mov_b32 s43, 0
    s_mov_b32 s83, 0x4b800000
    s_add_u32 m0, s84, 16384
    s_add_u32 s37, s85, 16384
    buffer_load_dwordx4 v16, s[12:15], s37 offen offset:0 nt lds
    buffer_load_dwordx4 v17, s[12:15], s37 offen offset:1024 nt lds
    buffer_load_dwordx4 v18, s[12:15], s37 offen offset:2048 nt lds
    buffer_load_dwordx4 v19, s[12:15], s37 offen offset:3072 nt lds
    s_add_u32 s4, s34, 0
    s_add_u32 m0, s33, 0
    s_nop 0
    buffer_load_dwordx4 v16, s[16:19], s4 offen offset:0 nt lds
    buffer_load_dwordx4 v17, s[16:19], s4 offen offset:1024 nt lds
    buffer_load_dwordx4 v18, s[16:19], s4 offen offset:2048 nt lds
    buffer_load_dwordx4 v19, s[16:19], s4 offen offset:3072 nt lds
    s_add_u32 s8, s34, 4096
    s_add_u32 m0, s33, 8192
    s_nop 0
    buffer_load_dwordx4 v16, s[16:19], s8 offen offset:0 nt lds
    buffer_load_dwordx4 v17, s[16:19], s8 offen offset:1024 nt lds
    buffer_load_dwordx4 v18, s[16:19], s8 offen offset:2048 nt lds
    buffer_load_dwordx4 v19, s[16:19], s8 offen offset:3072 nt lds
    s_waitcnt vmcnt(8)
    s_barrier
    ds_read_b128 a[0:3], v24 offset:0
    ds_read_b128 a[4:7], v25 offset:0
    ds_read_b128 a[8:11], v26 offset:0
    ds_read_b128 a[12:15], v27 offset:0
    ds_read_b128 a[16:19], v24 offset:256
    ds_read_b128 a[20:23], v25 offset:256
    ds_read_b128 a[24:27], v26 offset:256
    ds_read_b128 a[28:31], v27 offset:256
    s_add_u32 s4, s34, 8192
    s_add_u32 m0, s33, 16384
    s_nop 0
    buffer_load_dwordx4 v16, s[16:19], s4 offen offset:0 nt lds
    buffer_load_dwordx4 v17, s[16:19], s4 offen offset:1024 nt lds
    buffer_load_dwordx4 v18, s[16:19], s4 offen offset:2048 nt lds
    buffer_load_dwordx4 v19, s[16:19], s4 offen offset:3072 nt lds
    ds_read_b128 a[32:35], v24 offset:8192
    ds_read_b128 a[36:39], v25 offset:8192
    ds_read_b128 a[40:43], v26 offset:8192
    ds_read_b128 a[44:47], v27 offset:8192
    ds_read_b128 a[48:51], v24 offset:8448
    ds_read_b128 a[52:55], v25 offset:8448
    ds_read_b128 a[56:59], v26 offset:8448
    s_waitcnt lgkmcnt(11)
    ds_read_b128 a[60:63], v27 offset:8448
    ds_read_b128 a[64:67], v24 offset:16384
    ds_read_b128 a[68:71], v25 offset:16384
    ds_read_b128 a[72:75], v26 offset:16384
    s_waitcnt lgkmcnt(11)
    ds_read_b128 a[76:79], v27 offset:16384
    ds_read_b128 a[80:83], v24 offset:16640
    ds_read_b128 a[84:87], v25 offset:16640
    ds_read_b128 a[88:91], v26 offset:16640
    s_waitcnt lgkmcnt(11)
    ds_read_b128 a[92:95], v27 offset:16640
L_main:
    s_waitcnt vmcnt(8)
    s_waitcnt lgkmcnt(0)
    s_barrier
    ds_read_b128 a[96:99], v20 offset:0
    ds_read_b128 a[100:103], v21 offset:0
    ds_read_b128 a[104:107], v22 offset:0
    ds_read_b128 a[108:111], v23 offset:0
    ds_read_b128 a[112:115], v20 offset:256
    ds_read_b128 a[116:119], v21 offset:256
    ds_read_b128 a[120:123], v22 offset:256
    ds_read_b128 a[124:127], v23 offset:256
    s_waitcnt lgkmcnt(6)
    v_mfma_f32_16x16x32_bf16 v[64:67], a[96:99], a[0:3], 0
    s_add_u32 s8, s34, 12288
    s_add_u32 m0, s33, 24576
    v_mfma_f32_16x16x32_bf16 v[64:67], a[100:103], a[4:7], v[64:67]
    s_waitcnt lgkmcnt(4)
    v_mfma_f32_16x16x32_bf16 v[64:67], a[104:107], a[8:11], v[64:67]
    buffer_load_dwordx4 v16, s[16:19], s8 offen offset:0 nt lds
    v_mfma_f32_16x16x32_bf16 v[64:67], a[108:111], a[12:15], v[64:67]
    s_waitcnt lgkmcnt(2)
    v_mfma_f32_16x16x32_bf16 v[64:67], a[112:115], a[16:19], v[64:67]
    v_mfma_f32_16x16x32_bf16 v[64:67], a[116:119], a[20:23], v[64:67]
    s_waitcnt lgkmcnt(0)
    buffer_load_dwordx4 v17, s[16:19], s8 offen offset:1024 nt lds
    v_mfma_f32_16x16x32_bf16 v[64:67], a[120:123], a[24:27], v[64:67]
    v_mfma_f32_16x16x32_bf16 v[64:67], a[124:127], a[28:31], v[64:67]
    v_mfma_f32_16x16x32_bf16 v[72:75], a[96:99], a[32:35], 0
    buffer_load_dwordx4 v18, s[16:19], s8 offen offset:2048 nt lds
    v_mfma_f32_16x16x32_bf16 v[72:75], a[100:103], a[36:39], v[72:75]
    v_mfma_f32_16x16x32_bf16 v[72:75], a[104:107], a[40:43], v[72:75]
    v_mfma_f32_16x16x32_bf16 v[72:75], a[108:111], a[44:47], v[72:75]
    buffer_load_dwordx4 v19, s[16:19], s8 offen offset:3072 nt lds
    v_mfma_f32_16x16x32_bf16 v[72:75], a[112:115], a[48:51], v[72:75]
    s_add_u32 s88, s52, 0
    s_add_u32 m0, s51, 0
    v_mfma_f32_16x16x32_bf16 v[72:75], a[116:119], a[52:55], v[72:75]
    buffer_load_dwordx4 v6, s[20:23], s88 offen offset:0 nt lds
    v_mfma_f32_16x16x32_bf16 v[72:75], a[120:123], a[56:59], v[72:75]
    v_mfma_f32_16x16x32_bf16 v[72:75], a[124:127], a[60:63], v[72:75]
    s_waitcnt vmcnt(9) lgkmcnt(0)
    s_barrier
    v_mfma_f32_16x16x32_bf16 v[80:83], a[96:99], a[64:67], 0
    ds_read_b128 a[128:131], v20 offset:8192
    ds_read_b128 a[132:135], v21 offset:8192
    v_mfma_f32_16x16x32_bf16 v[80:83], a[100:103], a[68:71], v[80:83]
    buffer_load_dword v32, off, s[28:31], s41 sc1
    v_mfma_f32_16x16x32_bf16 v[80:83], a[104:107], a[72:75], v[80:83]
    ds_read_b128 a[136:139], v22 offset:8192
    ds_read_b128 a[140:143], v23 offset:8192
    v_mfma_f32_16x16x32_bf16 v[80:83], a[108:111], a[76:79], v[80:83]
    buffer_load_dword v33, off, s[28:31], s40 sc1
    v_mfma_f32_16x16x32_bf16 v[80:83], a[112:115], a[80:83], v[80:83]
    s_add_u32 s4, s34, 16384
    s_add_u32 m0, s33, 32768
    ds_read_b128 a[144:147], v20 offset:8448
    ds_read_b128 a[148:151], v21 offset:8448
    v_mfma_f32_16x16x32_bf16 v[80:83], a[116:119], a[84:87], v[80:83]
    buffer_load_dwordx4 v16, s[16:19], s4 offen offset:0 nt lds
    v_mfma_f32_16x16x32_bf16 v[80:83], a[120:123], a[88:91], v[80:83]
    ds_read_b128 a[152:155], v22 offset:8448
    ds_read_b128 a[156:159], v23 offset:8448
    v_mfma_f32_16x16x32_bf16 v[80:83], a[124:127], a[92:95], v[80:83]
    s_waitcnt lgkmcnt(6)
    buffer_load_dwordx4 v17, s[16:19], s4 offen offset:1024 nt lds
    v_mfma_f32_16x16x32_bf16 v[68:71], a[128:131], a[0:3], 0
    v_mfma_f32_16x16x32_bf16 v[68:71], a[132:135], a[4:7], v[68:71]
    s_waitcnt lgkmcnt(4)
    v_mfma_f32_16x16x32_bf16 v[68:71], a[136:139], a[8:11], v[68:71]
    buffer_load_dwordx4 v18, s[16:19], s4 offen offset:2048 nt lds
    v_max3_f32 v2, v64, v65, v66
    v_max3_f32 v3, v72, v73, v74
    v_mfma_f32_16x16x32_bf16 v[68:71], a[140:143], a[12:15], v[68:71]
    s_waitcnt lgkmcnt(2)
    v_max3_f32 v4, v80, v81, v82
    v_max_f32 v2, v2, v67
    v_mfma_f32_16x16x32_bf16 v[68:71], a[144:147], a[16:19], v[68:71]
    v_max_f32 v3, v3, v75
    v_max_f32 v4, v4, v83
    v_mov_b32 v36, v2
    v_mfma_f32_16x16x32_bf16 v[68:71], a[148:151], a[20:23], v[68:71]
    s_waitcnt lgkmcnt(0)
    buffer_load_dwordx4 v19, s[16:19], s4 offen offset:3072 nt lds
    v_mfma_f32_16x16x32_bf16 v[68:71], a[152:155], a[24:27], v[68:71]
    v_mov_b32 v37, v3
    v_mov_b32 v38, v4
    v_mfma_f32_16x16x32_bf16 v[68:71], a[156:159], a[28:31], v[68:71]
    s_add_u32 m0, s51, 0
    s_add_u32 s89, s52, 64512
    v_permlane32_swap_b32 v2, v36
    v_permlane32_swap_b32 v3, v37
    v_permlane32_swap_b32 v4, v38
    v_mfma_f32_16x16x32_bf16 v[76:79], a[128:131], a[32:35], 0
    buffer_load_dwordx4 v6, s[20:23], s89 offen offset:1024 nt lds
    v_mfma_f32_16x16x32_bf16 v[76:79], a[132:135], a[36:39], v[76:79]
    v_max_f32 v2, v2, v36
    v_max_f32 v3, v3, v37
    v_mfma_f32_16x16x32_bf16 v[76:79], a[136:139], a[40:43], v[76:79]
    s_add_u32 s90, s52, 2048
    v_max_f32 v4, v4, v38
    v_mov_b32 v36, v2
    v_mfma_f32_16x16x32_bf16 v[76:79], a[140:143], a[44:47], v[76:79]
    buffer_load_dwordx4 v6, s[20:23], s90 offen offset:2048 nt lds
    v_mfma_f32_16x16x32_bf16 v[76:79], a[144:147], a[48:51], v[76:79]
    v_mov_b32 v37, v3
    v_mov_b32 v38, v4
    v_permlane16_swap_b32 v2, v36
    v_mfma_f32_16x16x32_bf16 v[76:79], a[148:151], a[52:55], v[76:79]
    v_permlane16_swap_b32 v3, v37
    v_permlane16_swap_b32 v4, v38
    v_mfma_f32_16x16x32_bf16 v[76:79], a[152:155], a[56:59], v[76:79]
    v_max_f32 v2, v2, v36
    v_max_f32 v3, v3, v37
    v_max_f32 v4, v4, v38
    v_mfma_f32_16x16x32_bf16 v[76:79], a[156:159], a[60:63], v[76:79]
    ds_write_b128 v7, v[2:5]
    s_waitcnt vmcnt(13) lgkmcnt(0)
    s_barrier
    v_mfma_f32_16x16x32_bf16 v[84:87], a[128:131], a[64:67], 0
    s_add_u32 s8, s34, 20480
    s_add_u32 m0, s33, 40960
    ds_read_b128 v[36:39], v15
    ds_read_b128 a[96:99], v20 offset:16384
    ds_read_b128 a[100:103], v21 offset:16384
    v_mfma_f32_16x16x32_bf16 v[84:87], a[132:135], a[68:71], v[84:87]
    buffer_load_dwordx4 v16, s[16:19], s8 offen offset:0 nt lds
    v_mfma_f32_16x16x32_bf16 v[84:87], a[136:139], a[72:75], v[84:87]
    ds_read_b128 a[104:107], v22 offset:16384
    ds_read_b128 a[108:111], v23 offset:16384
    v_mfma_f32_16x16x32_bf16 v[84:87], a[140:143], a[76:79], v[84:87]
    buffer_load_dwordx4 v17, s[16:19], s8 offen offset:1024 nt lds
    v_mfma_f32_16x16x32_bf16 v[84:87], a[144:147], a[80:83], v[84:87]
    ds_read_b128 a[112:115], v20 offset:16640
    ds_read_b128 a[116:119], v21 offset:16640
    v_mfma_f32_16x16x32_bf16 v[84:87], a[148:151], a[84:87], v[84:87]
    buffer_load_dwordx4 v18, s[16:19], s8 offen offset:2048 nt lds
    v_mfma_f32_16x16x32_bf16 v[84:87], a[152:155], a[88:91], v[84:87]
    ds_read_b128 a[120:123], v22 offset:16640
    ds_read_b128 a[124:127], v23 offset:16640
    v_mfma_f32_16x16x32_bf16 v[84:87], a[156:159], a[92:95], v[84:87]
    s_waitcnt lgkmcnt(6)
    buffer_load_dwordx4 v19, s[16:19], s8 offen offset:3072 nt lds
    v_mfma_f32_16x16x32_bf16 v[88:91], a[96:99], a[0:3], 0
    v_max_f32 v2, v2, v36
    v_max_f32 v3, v3, v37
    v_max_f32 v4, v4, v38
    v_mul_f32 v2, s38, v2
    v_mul_f32 v3, s38, v3
    v_mfma_f32_16x16x32_bf16 v[88:91], a[100:103], a[4:7], v[88:91]
    s_waitcnt lgkmcnt(4)
    s_add_u32 m0, s51, 0
    s_add_u32 s91, s52, 66560
    v_mul_f32 v4, s38, v4
    v_ceil_f32 v2, v2
    v_ceil_f32 v3, v3
    v_ceil_f32 v4, v4
    v_accvgpr_read_b32 v36, a172
    v_mfma_f32_16x16x32_bf16 v[88:91], a[104:107], a[8:11], v[88:91]
    buffer_load_dwordx4 v6, s[20:23], s91 offen offset:3072 nt lds
    v_accvgpr_read_b32 v37, a173
    v_accvgpr_read_b32 v38, a174
    v_max_f32 v2, v2, v36
    v_mfma_f32_16x16x32_bf16 v[88:91], a[108:111], a[12:15], v[88:91]
    s_waitcnt lgkmcnt(2)
    v_max_f32 v3, v3, v37
    v_max_f32 v4, v4, v38
    v_mfma_f32_16x16x32_bf16 v[88:91], a[112:115], a[16:19], v[88:91]
    s_add_u32 s88, s52, 16384
    s_add_u32 m0, s51, 8192
    v_mfma_f32_16x16x32_bf16 v[88:91], a[116:119], a[20:23], v[88:91]
    s_waitcnt lgkmcnt(0)
    buffer_load_dwordx4 v6, s[20:23], s88 offen offset:0 nt lds
    v_mfma_f32_16x16x32_bf16 v[88:91], a[120:123], a[24:27], v[88:91]
    v_mfma_f32_16x16x32_bf16 v[88:91], a[124:127], a[28:31], v[88:91]
    v_mfma_f32_16x16x32_bf16 v[96:99], a[96:99], a[32:35], 0
    v_mfma_f32_16x16x32_bf16 v[96:99], a[100:103], a[36:39], v[96:99]
    v_mfma_f32_16x16x32_bf16 v[96:99], a[104:107], a[40:43], v[96:99]
    v_mfma_f32_16x16x32_bf16 v[96:99], a[108:111], a[44:47], v[96:99]
    v_mfma_f32_16x16x32_bf16 v[96:99], a[112:115], a[48:51], v[96:99]
    v_mfma_f32_16x16x32_bf16 v[96:99], a[116:119], a[52:55], v[96:99]
    v_mfma_f32_16x16x32_bf16 v[96:99], a[120:123], a[56:59], v[96:99]
    v_mfma_f32_16x16x32_bf16 v[96:99], a[124:127], a[60:63], v[96:99]
    s_waitcnt vmcnt(15) lgkmcnt(0)
    s_barrier
    v_mfma_f32_16x16x32_bf16 v[104:107], a[96:99], a[64:67], 0
    s_add_u32 s4, s34, 24576
    s_add_u32 m0, s33, 0
    ds_read_b128 a[128:131], v20 offset:24576
    ds_read_b128 a[132:135], v21 offset:24576
    v_mfma_f32_16x16x32_bf16 v[104:107], a[100:103], a[68:71], v[104:107]
    buffer_load_dwordx4 v16, s[16:19], s4 offen offset:0 nt lds
    v_mfma_f32_16x16x32_bf16 v[104:107], a[104:107], a[72:75], v[104:107]
    ds_read_b128 a[136:139], v22 offset:24576
    ds_read_b128 a[140:143], v23 offset:24576
    v_mfma_f32_16x16x32_bf16 v[104:107], a[108:111], a[76:79], v[104:107]
    buffer_load_dwordx4 v17, s[16:19], s4 offen offset:1024 nt lds
    v_mfma_f32_16x16x32_bf16 v[104:107], a[112:115], a[80:83], v[104:107]
    ds_read_b128 a[144:147], v20 offset:24832
    ds_read_b128 a[148:151], v21 offset:24832
    v_mfma_f32_16x16x32_bf16 v[104:107], a[116:119], a[84:87], v[104:107]
    buffer_load_dwordx4 v18, s[16:19], s4 offen offset:2048 nt lds
    v_mfma_f32_16x16x32_bf16 v[104:107], a[120:123], a[88:91], v[104:107]
    ds_read_b128 a[152:155], v22 offset:24832
    ds_read_b128 a[156:159], v23 offset:24832
    v_mfma_f32_16x16x32_bf16 v[104:107], a[124:127], a[92:95], v[104:107]
    s_waitcnt lgkmcnt(6)
    buffer_load_dwordx4 v19, s[16:19], s4 offen offset:3072 nt lds
    v_mfma_f32_16x16x32_bf16 v[92:95], a[128:131], a[0:3], 0
    v_mfma_f32_16x16x32_bf16 v[92:95], a[132:135], a[4:7], v[92:95]
    s_waitcnt lgkmcnt(4)
    s_add_u32 m0, s51, 8192
    s_add_u32 s89, s52, 80896
    v_mfma_f32_16x16x32_bf16 v[92:95], a[136:139], a[8:11], v[92:95]
    buffer_load_dwordx4 v6, s[20:23], s89 offen offset:1024 nt lds
    v_mfma_f32_16x16x32_bf16 v[92:95], a[140:143], a[12:15], v[92:95]
    s_waitcnt lgkmcnt(2)
    v_mfma_f32_16x16x32_bf16 v[92:95], a[144:147], a[16:19], v[92:95]
    v_mfma_f32_16x16x32_bf16 v[92:95], a[148:151], a[20:23], v[92:95]
    s_waitcnt lgkmcnt(0)
    v_mfma_f32_16x16x32_bf16 v[92:95], a[152:155], a[24:27], v[92:95]
    v_mfma_f32_16x16x32_bf16 v[92:95], a[156:159], a[28:31], v[92:95]
    v_mfma_f32_16x16x32_bf16 v[100:103], a[128:131], a[32:35], 0
    v_mfma_f32_16x16x32_bf16 v[100:103], a[132:135], a[36:39], v[100:103]
    v_mfma_f32_16x16x32_bf16 v[100:103], a[136:139], a[40:43], v[100:103]
    v_mfma_f32_16x16x32_bf16 v[100:103], a[140:143], a[44:47], v[100:103]
    v_mfma_f32_16x16x32_bf16 v[100:103], a[144:147], a[48:51], v[100:103]
    v_mfma_f32_16x16x32_bf16 v[100:103], a[148:151], a[52:55], v[100:103]
    v_mfma_f32_16x16x32_bf16 v[100:103], a[152:155], a[56:59], v[100:103]
    v_mfma_f32_16x16x32_bf16 v[100:103], a[156:159], a[60:63], v[100:103]
    s_waitcnt vmcnt(13) lgkmcnt(0)
    s_barrier
    v_mfma_f32_16x16x32_bf16 v[108:111], a[128:131], a[64:67], 0
    s_add_u32 s8, s34, 28672
    s_add_u32 m0, s33, 8192
    ds_read_b128 a[96:99], v20 offset:32768
    ds_read_b128 a[100:103], v21 offset:32768
    v_mfma_f32_16x16x32_bf16 v[108:111], a[132:135], a[68:71], v[108:111]
    buffer_load_dwordx4 v16, s[16:19], s8 offen offset:0 nt lds
    v_mfma_f32_16x16x32_bf16 v[108:111], a[136:139], a[72:75], v[108:111]
    ds_read_b128 a[104:107], v22 offset:32768
    ds_read_b128 a[108:111], v23 offset:32768
    v_mfma_f32_16x16x32_bf16 v[108:111], a[140:143], a[76:79], v[108:111]
    buffer_load_dwordx4 v17, s[16:19], s8 offen offset:1024 nt lds
    v_mfma_f32_16x16x32_bf16 v[108:111], a[144:147], a[80:83], v[108:111]
    ds_read_b128 a[112:115], v20 offset:33024
    ds_read_b128 a[116:119], v21 offset:33024
    v_mfma_f32_16x16x32_bf16 v[108:111], a[148:151], a[84:87], v[108:111]
    buffer_load_dwordx4 v18, s[16:19], s8 offen offset:2048 nt lds
    v_mfma_f32_16x16x32_bf16 v[108:111], a[152:155], a[88:91], v[108:111]
    ds_read_b128 a[120:123], v22 offset:33024
    ds_read_b128 a[124:127], v23 offset:33024
    v_mfma_f32_16x16x32_bf16 v[108:111], a[156:159], a[92:95], v[108:111]
    s_waitcnt lgkmcnt(6)
    buffer_load_dwordx4 v19, s[16:19], s8 offen offset:3072 nt lds
    v_mfma_f32_16x16x32_bf16 v[112:115], a[96:99], a[0:3], 0
    v_mfma_f32_16x16x32_bf16 v[112:115], a[100:103], a[4:7], v[112:115]
    s_waitcnt lgkmcnt(4)
    s_add_u32 m0, s51, 8192
    s_add_u32 s90, s52, 18432
    v_mfma_f32_16x16x32_bf16 v[112:115], a[104:107], a[8:11], v[112:115]
    buffer_load_dwordx4 v6, s[20:23], s90 offen offset:2048 nt lds
    v_mfma_f32_16x16x32_bf16 v[112:115], a[108:111], a[12:15], v[112:115]
    s_waitcnt lgkmcnt(2)
    v_mfma_f32_16x16x32_bf16 v[112:115], a[112:115], a[16:19], v[112:115]
    v_mfma_f32_16x16x32_bf16 v[112:115], a[116:119], a[20:23], v[112:115]
    s_waitcnt lgkmcnt(0)
    v_mfma_f32_16x16x32_bf16 v[112:115], a[120:123], a[24:27], v[112:115]
    v_mfma_f32_16x16x32_bf16 v[112:115], a[124:127], a[28:31], v[112:115]
    v_mfma_f32_16x16x32_bf16 v[120:123], a[96:99], a[32:35], 0
    v_mfma_f32_16x16x32_bf16 v[120:123], a[100:103], a[36:39], v[120:123]
    v_mfma_f32_16x16x32_bf16 v[120:123], a[104:107], a[40:43], v[120:123]
    v_mfma_f32_16x16x32_bf16 v[120:123], a[108:111], a[44:47], v[120:123]
    v_mfma_f32_16x16x32_bf16 v[120:123], a[112:115], a[48:51], v[120:123]
    v_mfma_f32_16x16x32_bf16 v[120:123], a[116:119], a[52:55], v[120:123]
    v_mfma_f32_16x16x32_bf16 v[120:123], a[120:123], a[56:59], v[120:123]
    v_mfma_f32_16x16x32_bf16 v[120:123], a[124:127], a[60:63], v[120:123]
    v_readfirstlane_b32 s47, v32
    v_readfirstlane_b32 s48, v33
    s_getreg_b32 s35, hwreg(HW_REG_XCC_ID, 0, 4)
    s_add_u32 s47, s47, 1
    s_add_u32 s48, s48, 1
    s_cmp_eq_u32 s82, 0
    s_cselect_b32 s42, s47, s42
    s_cselect_b32 s43, s48, s43
    v_mov_b32 v32, s42
    v_mov_b32 v33, s35
    s_mov_b64 exec, 1
    buffer_store_dwordx2 v[32:33], off, s[28:31], s40 offset:8 sc1
    s_mov_b64 exec, -1
    s_waitcnt vmcnt(13) lgkmcnt(0)
    s_barrier
    v_mfma_f32_16x16x32_bf16 v[128:131], a[96:99], a[64:67], 0
    s_add_u32 s4, s34, 32768
    s_add_u32 m0, s33, 16384
    ds_read_b128 a[128:131], v20 offset:40960
    ds_read_b128 a[132:135], v21 offset:40960
    v_mfma_f32_16x16x32_bf16 v[128:131], a[100:103], a[68:71], v[128:131]
    buffer_load_dwordx4 v16, s[16:19], s4 offen offset:0 nt lds
    v_mfma_f32_16x16x32_bf16 v[128:131], a[104:107], a[72:75], v[128:131]
    ds_read_b128 a[136:139], v22 offset:40960
    ds_read_b128 a[140:143], v23 offset:40960
    v_mfma_f32_16x16x32_bf16 v[128:131], a[108:111], a[76:79], v[128:131]
    buffer_load_dwordx4 v17, s[16:19], s4 offen offset:1024 nt lds
    v_mfma_f32_16x16x32_bf16 v[128:131], a[112:115], a[80:83], v[128:131]
    ds_read_b128 a[144:147], v20 offset:41216
    ds_read_b128 a[148:151], v21 offset:41216
    v_mfma_f32_16x16x32_bf16 v[128:131], a[116:119], a[84:87], v[128:131]
    buffer_load_dwordx4 v18, s[16:19], s4 offen offset:2048 nt lds
    v_mfma_f32_16x16x32_bf16 v[128:131], a[120:123], a[88:91], v[128:131]
    ds_read_b128 a[152:155], v22 offset:41216
    ds_read_b128 a[156:159], v23 offset:41216
    v_mfma_f32_16x16x32_bf16 v[128:131], a[124:127], a[92:95], v[128:131]
    s_waitcnt lgkmcnt(6)
    buffer_load_dwordx4 v19, s[16:19], s4 offen offset:3072 nt lds
    v_mfma_f32_16x16x32_bf16 v[116:119], a[128:131], a[0:3], 0
    v_mfma_f32_16x16x32_bf16 v[116:119], a[132:135], a[4:7], v[116:119]
    s_waitcnt lgkmcnt(4)
    v_mfma_f32_16x16x32_bf16 v[116:119], a[136:139], a[8:11], v[116:119]
    v_mfma_f32_16x16x32_bf16 v[116:119], a[140:143], a[12:15], v[116:119]
    s_waitcnt lgkmcnt(2)
    v_mfma_f32_16x16x32_bf16 v[116:119], a[144:147], a[16:19], v[116:119]
    v_mfma_f32_16x16x32_bf16 v[116:119], a[148:151], a[20:23], v[116:119]
    s_waitcnt lgkmcnt(0)
    v_mfma_f32_16x16x32_bf16 v[116:119], a[152:155], a[24:27], v[116:119]
    v_mfma_f32_16x16x32_bf16 v[116:119], a[156:159], a[28:31], v[116:119]
    v_mfma_f32_16x16x32_bf16 v[124:127], a[128:131], a[32:35], 0
    v_mfma_f32_16x16x32_bf16 v[124:127], a[132:135], a[36:39], v[124:127]
    v_mfma_f32_16x16x32_bf16 v[124:127], a[136:139], a[40:43], v[124:127]
    v_mfma_f32_16x16x32_bf16 v[124:127], a[140:143], a[44:47], v[124:127]
    v_mfma_f32_16x16x32_bf16 v[124:127], a[144:147], a[48:51], v[124:127]
    v_mfma_f32_16x16x32_bf16 v[124:127], a[148:151], a[52:55], v[124:127]
    v_mfma_f32_16x16x32_bf16 v[124:127], a[152:155], a[56:59], v[124:127]
    v_mfma_f32_16x16x32_bf16 v[124:127], a[156:159], a[60:63], v[124:127]
    s_waitcnt vmcnt(11) lgkmcnt(0)
    s_barrier
    v_mfma_f32_16x16x32_bf16 v[132:135], a[128:131], a[64:67], 0
    s_add_u32 s8, s34, 36864
    s_add_u32 m0, s33, 24576
    ds_read_b128 a[96:99], v20 offset:0
    ds_read_b128 a[100:103], v21 offset:0
    v_mfma_f32_16x16x32_bf16 v[132:135], a[132:135], a[68:71], v[132:135]
    buffer_load_dwordx4 v16, s[16:19], s8 offen offset:0 nt lds
    v_mfma_f32_16x16x32_bf16 v[132:135], a[136:139], a[72:75], v[132:135]
    ds_read_b128 a[104:107], v22 offset:0
    ds_read_b128 a[108:111], v23 offset:0
    v_mfma_f32_16x16x32_bf16 v[132:135], a[140:143], a[76:79], v[132:135]
    buffer_load_dwordx4 v17, s[16:19], s8 offen offset:1024 nt lds
    v_mfma_f32_16x16x32_bf16 v[132:135], a[144:147], a[80:83], v[132:135]
    ds_read_b128 a[112:115], v20 offset:256
    ds_read_b128 a[116:119], v21 offset:256
    v_mfma_f32_16x16x32_bf16 v[132:135], a[148:151], a[84:87], v[132:135]
    buffer_load_dwordx4 v18, s[16:19], s8 offen offset:2048 nt lds
    v_mfma_f32_16x16x32_bf16 v[132:135], a[152:155], a[88:91], v[132:135]
    ds_read_b128 a[120:123], v22 offset:256
    ds_read_b128 a[124:127], v23 offset:256
    v_mfma_f32_16x16x32_bf16 v[132:135], a[156:159], a[92:95], v[132:135]
    s_waitcnt lgkmcnt(6)
    buffer_load_dwordx4 v19, s[16:19], s8 offen offset:3072 nt lds
    v_mfma_f32_16x16x32_bf16 v[136:139], a[96:99], a[0:3], 0
    v_mfma_f32_16x16x32_bf16 v[136:139], a[100:103], a[4:7], v[136:139]
    s_waitcnt lgkmcnt(4)
    s_add_u32 m0, s51, 8192
    s_add_u32 s91, s52, 82944
    v_mfma_f32_16x16x32_bf16 v[136:139], a[104:107], a[8:11], v[136:139]
    buffer_load_dwordx4 v6, s[20:23], s91 offen offset:3072 nt lds
    v_mfma_f32_16x16x32_bf16 v[136:139], a[108:111], a[12:15], v[136:139]
    s_waitcnt lgkmcnt(2)
    v_mfma_f32_16x16x32_bf16 v[136:139], a[112:115], a[16:19], v[136:139]
    v_mfma_f32_16x16x32_bf16 v[136:139], a[116:119], a[20:23], v[136:139]
    s_waitcnt lgkmcnt(0)
    v_mfma_f32_16x16x32_bf16 v[136:139], a[120:123], a[24:27], v[136:139]
    v_mfma_f32_16x16x32_bf16 v[136:139], a[124:127], a[28:31], v[136:139]
    v_mfma_f32_16x16x32_bf16 v[144:147], a[96:99], a[32:35], 0
    v_mfma_f32_16x16x32_bf16 v[144:147], a[100:103], a[36:39], v[144:147]
    v_mfma_f32_16x16x32_bf16 v[144:147], a[104:107], a[40:43], v[144:147]
    v_mfma_f32_16x16x32_bf16 v[144:147], a[108:111], a[44:47], v[144:147]
    v_mfma_f32_16x16x32_bf16 v[144:147], a[112:115], a[48:51], v[144:147]
    v_mfma_f32_16x16x32_bf16 v[144:147], a[116:119], a[52:55], v[144:147]
    v_mfma_f32_16x16x32_bf16 v[144:147], a[120:123], a[56:59], v[144:147]
    v_mfma_f32_16x16x32_bf16 v[144:147], a[124:127], a[60:63], v[144:147]
    s_waitcnt vmcnt(11) lgkmcnt(0)
    s_barrier
    v_mfma_f32_16x16x32_bf16 v[152:155], a[96:99], a[64:67], 0
    s_add_u32 s4, s34, 40960
    s_add_u32 m0, s33, 32768
    ds_read_b128 a[128:131], v20 offset:8192
    ds_read_b128 a[132:135], v21 offset:8192
    v_mfma_f32_16x16x32_bf16 v[152:155], a[100:103], a[68:71], v[152:155]
    buffer_load_dwordx4 v16, s[16:19], s4 offen offset:0 nt lds
    v_mfma_f32_16x16x32_bf16 v[152:155], a[104:107], a[72:75], v[152:155]
    ds_read_b128 a[136:139], v22 offset:8192
    ds_read_b128 a[140:143], v23 offset:8192
    v_mfma_f32_16x16x32_bf16 v[152:155], a[108:111], a[76:79], v[152:155]
    buffer_load_dwordx4 v17, s[16:19], s4 offen offset:1024 nt lds
    v_mfma_f32_16x16x32_bf16 v[152:155], a[112:115], a[80:83], v[152:155]
    ds_read_b128 a[144:147], v20 offset:8448
    ds_read_b128 a[148:151], v21 offset:8448
    v_mfma_f32_16x16x32_bf16 v[152:155], a[116:119], a[84:87], v[152:155]
    buffer_load_dwordx4 v18, s[16:19], s4 offen offset:2048 nt lds
    v_mfma_f32_16x16x32_bf16 v[152:155], a[120:123], a[88:91], v[152:155]
    ds_read_b128 a[152:155], v22 offset:8448
    ds_read_b128 a[156:159], v23 offset:8448
    v_mfma_f32_16x16x32_bf16 v[152:155], a[124:127], a[92:95], v[152:155]
    s_waitcnt lgkmcnt(6)
    buffer_load_dwordx4 v19, s[16:19], s4 offen offset:3072 nt lds
    v_mfma_f32_16x16x32_bf16 v[140:143], a[128:131], a[0:3], 0
    v_mfma_f32_16x16x32_bf16 v[140:143], a[132:135], a[4:7], v[140:143]
    s_waitcnt lgkmcnt(4)
    v_mfma_f32_16x16x32_bf16 v[140:143], a[136:139], a[8:11], v[140:143]
    v_mfma_f32_16x16x32_bf16 v[140:143], a[140:143], a[12:15], v[140:143]
    s_waitcnt lgkmcnt(2)
    v_mfma_f32_16x16x32_bf16 v[140:143], a[144:147], a[16:19], v[140:143]
    v_mfma_f32_16x16x32_bf16 v[140:143], a[148:151], a[20:23], v[140:143]
    s_waitcnt lgkmcnt(0)
    v_mfma_f32_16x16x32_bf16 v[140:143], a[152:155], a[24:27], v[140:143]
    v_mfma_f32_16x16x32_bf16 v[140:143], a[156:159], a[28:31], v[140:143]
    v_mfma_f32_16x16x32_bf16 v[148:151], a[128:131], a[32:35], 0
    v_mfma_f32_16x16x32_bf16 v[148:151], a[132:135], a[36:39], v[148:151]
    v_mfma_f32_16x16x32_bf16 v[148:151], a[136:139], a[40:43], v[148:151]
    v_mfma_f32_16x16x32_bf16 v[148:151], a[140:143], a[44:47], v[148:151]
    v_mfma_f32_16x16x32_bf16 v[148:151], a[144:147], a[48:51], v[148:151]
    v_mfma_f32_16x16x32_bf16 v[148:151], a[148:151], a[52:55], v[148:151]
    v_mfma_f32_16x16x32_bf16 v[148:151], a[152:155], a[56:59], v[148:151]
    v_mfma_f32_16x16x32_bf16 v[148:151], a[156:159], a[60:63], v[148:151]
    s_waitcnt vmcnt(9) lgkmcnt(0)
    s_barrier
    v_mfma_f32_16x16x32_bf16 v[156:159], a[128:131], a[64:67], 0
    s_add_u32 s8, s34, 45056
    s_add_u32 m0, s33, 40960
    ds_read_b128 a[96:99], v20 offset:16384
    ds_read_b128 a[100:103], v21 offset:16384
    v_mfma_f32_16x16x32_bf16 v[156:159], a[132:135], a[68:71], v[156:159]
    buffer_load_dwordx4 v16, s[16:19], s8 offen offset:0 nt lds
    v_mfma_f32_16x16x32_bf16 v[156:159], a[136:139], a[72:75], v[156:159]
    ds_read_b128 a[104:107], v22 offset:16384
    ds_read_b128 a[108:111], v23 offset:16384
    v_mfma_f32_16x16x32_bf16 v[156:159], a[140:143], a[76:79], v[156:159]
    buffer_load_dwordx4 v17, s[16:19], s8 offen offset:1024 nt lds
    v_mfma_f32_16x16x32_bf16 v[156:159], a[144:147], a[80:83], v[156:159]
    ds_read_b128 a[112:115], v20 offset:16640
    ds_read_b128 a[116:119], v21 offset:16640
    v_mfma_f32_16x16x32_bf16 v[156:159], a[148:151], a[84:87], v[156:159]
    buffer_load_dwordx4 v18, s[16:19], s8 offen offset:2048 nt lds
    v_mfma_f32_16x16x32_bf16 v[156:159], a[152:155], a[88:91], v[156:159]
    ds_read_b128 a[120:123], v22 offset:16640
    ds_read_b128 a[124:127], v23 offset:16640
    v_mfma_f32_16x16x32_bf16 v[156:159], a[156:159], a[92:95], v[156:159]
    s_waitcnt lgkmcnt(6)
    buffer_load_dwordx4 v19, s[16:19], s8 offen offset:3072 nt lds
    v_mfma_f32_16x16x32_bf16 v[160:163], a[96:99], a[0:3], 0
    v_mfma_f32_16x16x32_bf16 v[160:163], a[100:103], a[4:7], v[160:163]
    s_waitcnt lgkmcnt(4)
    v_mfma_f32_16x16x32_bf16 v[160:163], a[104:107], a[8:11], v[160:163]
    v_mfma_f32_16x16x32_bf16 v[160:163], a[108:111], a[12:15], v[160:163]
    s_waitcnt lgkmcnt(2)
    v_mfma_f32_16x16x32_bf16 v[160:163], a[112:115], a[16:19], v[160:163]
    v_mfma_f32_16x16x32_bf16 v[160:163], a[116:119], a[20:23], v[160:163]
    s_waitcnt lgkmcnt(0)
    v_mfma_f32_16x16x32_bf16 v[160:163], a[120:123], a[24:27], v[160:163]
    v_mfma_f32_16x16x32_bf16 v[160:163], a[124:127], a[28:31], v[160:163]
    v_mfma_f32_16x16x32_bf16 v[168:171], a[96:99], a[32:35], 0
    v_mfma_f32_16x16x32_bf16 v[168:171], a[100:103], a[36:39], v[168:171]
    v_mfma_f32_16x16x32_bf16 v[168:171], a[104:107], a[40:43], v[168:171]
    v_mfma_f32_16x16x32_bf16 v[168:171], a[108:111], a[44:47], v[168:171]
    v_mfma_f32_16x16x32_bf16 v[168:171], a[112:115], a[48:51], v[168:171]
    v_mfma_f32_16x16x32_bf16 v[168:171], a[116:119], a[52:55], v[168:171]
    v_mfma_f32_16x16x32_bf16 v[168:171], a[120:123], a[56:59], v[168:171]
    v_mfma_f32_16x16x32_bf16 v[168:171], a[124:127], a[60:63], v[168:171]
    s_waitcnt vmcnt(9) lgkmcnt(0)
    s_barrier
    v_mfma_f32_16x16x32_bf16 v[176:179], a[96:99], a[64:67], 0
    s_add_u32 s4, s34, 49152
    s_add_u32 m0, s33, 0
    ds_read_b128 a[128:131], v20 offset:24576
    ds_read_b128 a[132:135], v21 offset:24576
    v_mfma_f32_16x16x32_bf16 v[176:179], a[100:103], a[68:71], v[176:179]
    buffer_load_dwordx4 v16, s[16:19], s4 offen offset:0 nt lds
    v_mfma_f32_16x16x32_bf16 v[176:179], a[104:107], a[72:75], v[176:179]
    ds_read_b128 a[136:139], v22 offset:24576
    ds_read_b128 a[140:143], v23 offset:24576
    v_mfma_f32_16x16x32_bf16 v[176:179], a[108:111], a[76:79], v[176:179]
    buffer_load_dwordx4 v17, s[16:19], s4 offen offset:1024 nt lds
    v_mfma_f32_16x16x32_bf16 v[176:179], a[112:115], a[80:83], v[176:179]
    ds_read_b128 a[144:147], v20 offset:24832
    ds_read_b128 a[148:151], v21 offset:24832
    v_mfma_f32_16x16x32_bf16 v[176:179], a[116:119], a[84:87], v[176:179]
    buffer_load_dwordx4 v18, s[16:19], s4 offen offset:2048 nt lds
    v_mfma_f32_16x16x32_bf16 v[176:179], a[120:123], a[88:91], v[176:179]
    ds_read_b128 a[152:155], v22 offset:24832
    ds_read_b128 a[156:159], v23 offset:24832
    v_mfma_f32_16x16x32_bf16 v[176:179], a[124:127], a[92:95], v[176:179]
    s_waitcnt lgkmcnt(6)
    buffer_load_dwordx4 v19, s[16:19], s4 offen offset:3072 nt lds
    v_mfma_f32_16x16x32_bf16 v[164:167], a[128:131], a[0:3], 0
    v_mfma_f32_16x16x32_bf16 v[164:167], a[132:135], a[4:7], v[164:167]
    s_waitcnt lgkmcnt(4)
    v_mfma_f32_16x16x32_bf16 v[164:167], a[136:139], a[8:11], v[164:167]
    v_mfma_f32_16x16x32_bf16 v[164:167], a[140:143], a[12:15], v[164:167]
    s_waitcnt lgkmcnt(2)
    v_mfma_f32_16x16x32_bf16 v[164:167], a[144:147], a[16:19], v[164:167]
    v_mfma_f32_16x16x32_bf16 v[164:167], a[148:151], a[20:23], v[164:167]
    s_waitcnt lgkmcnt(0)
    v_mfma_f32_16x16x32_bf16 v[164:167], a[152:155], a[24:27], v[164:167]
    v_mfma_f32_16x16x32_bf16 v[164:167], a[156:159], a[28:31], v[164:167]
    v_mfma_f32_16x16x32_bf16 v[172:175], a[128:131], a[32:35], 0
    v_mfma_f32_16x16x32_bf16 v[172:175], a[132:135], a[36:39], v[172:175]
    v_mfma_f32_16x16x32_bf16 v[172:175], a[136:139], a[40:43], v[172:175]
    v_mfma_f32_16x16x32_bf16 v[172:175], a[140:143], a[44:47], v[172:175]
    v_mfma_f32_16x16x32_bf16 v[172:175], a[144:147], a[48:51], v[172:175]
    v_mfma_f32_16x16x32_bf16 v[172:175], a[148:151], a[52:55], v[172:175]
    v_mfma_f32_16x16x32_bf16 v[172:175], a[152:155], a[56:59], v[172:175]
    v_mfma_f32_16x16x32_bf16 v[172:175], a[156:159], a[60:63], v[172:175]
    buffer_load_dwordx2 v[34:35], off, s[28:31], s41 offset:8 sc1
    s_waitcnt vmcnt(9) lgkmcnt(0)
    s_barrier
    v_mfma_f32_16x16x32_bf16 v[180:183], a[128:131], a[64:67], 0
    s_add_u32 s8, s34, 53248
    s_add_u32 m0, s33, 8192
    ds_read_b128 a[96:99], v20 offset:32768
    ds_read_b128 a[100:103], v21 offset:32768
    v_mfma_f32_16x16x32_bf16 v[180:183], a[132:135], a[68:71], v[180:183]
    buffer_load_dwordx4 v16, s[16:19], s8 offen offset:0 nt lds
    v_mfma_f32_16x16x32_bf16 v[180:183], a[136:139], a[72:75], v[180:183]
    ds_read_b128 a[104:107], v22 offset:32768
    ds_read_b128 a[108:111], v23 offset:32768
    v_mfma_f32_16x16x32_bf16 v[180:183], a[140:143], a[76:79], v[180:183]
    buffer_load_dwordx4 v17, s[16:19], s8 offen offset:1024 nt lds
    v_mfma_f32_16x16x32_bf16 v[180:183], a[144:147], a[80:83], v[180:183]
    ds_read_b128 a[112:115], v20 offset:33024
    ds_read_b128 a[116:119], v21 offset:33024
    v_mfma_f32_16x16x32_bf16 v[180:183], a[148:151], a[84:87], v[180:183]
    buffer_load_dwordx4 v18, s[16:19], s8 offen offset:2048 nt lds
    v_mfma_f32_16x16x32_bf16 v[180:183], a[152:155], a[88:91], v[180:183]
    ds_read_b128 a[120:123], v22 offset:33024
    ds_read_b128 a[124:127], v23 offset:33024
    v_mfma_f32_16x16x32_bf16 v[180:183], a[156:159], a[92:95], v[180:183]
    s_waitcnt lgkmcnt(6)
    buffer_load_dwordx4 v19, s[16:19], s8 offen offset:3072 nt lds
    v_mfma_f32_16x16x32_bf16 v[184:187], a[96:99], a[0:3], 0
    v_fma_f32 v64, v64, s38, -v2
    v_exp_f32 v64, v64
    v_fma_f32 v65, v65, s38, -v2
    v_fma_f32 v66, v66, s38, -v2
    v_mfma_f32_16x16x32_bf16 v[184:187], a[100:103], a[4:7], v[184:187]
    s_waitcnt lgkmcnt(4)
    v_exp_f32 v65, v65
    v_exp_f32 v66, v66
    v_fma_f32 v67, v67, s38, -v2
    v_mfma_f32_16x16x32_bf16 v[184:187], a[104:107], a[8:11], v[184:187]
    v_exp_f32 v67, v67
    v_fma_f32 v72, v72, s38, -v3
    v_exp_f32 v72, v72
    v_mfma_f32_16x16x32_bf16 v[184:187], a[108:111], a[12:15], v[184:187]
    s_waitcnt lgkmcnt(2)
    v_fma_f32 v73, v73, s38, -v3
    v_exp_f32 v73, v73
    v_fma_f32 v74, v74, s38, -v3
    v_fma_f32 v75, v75, s38, -v3
    v_mfma_f32_16x16x32_bf16 v[184:187], a[112:115], a[16:19], v[184:187]
    v_exp_f32 v74, v74
    v_exp_f32 v75, v75
    v_cvt_pk_bf16_f32 v64, v64, v65
    v_mfma_f32_16x16x32_bf16 v[184:187], a[116:119], a[20:23], v[184:187]
    s_waitcnt lgkmcnt(0)
    v_cvt_pk_bf16_f32 v65, v66, v67
    v_fma_f32 v80, v80, s38, -v4
    v_exp_f32 v80, v80
    v_fma_f32 v81, v81, s38, -v4
    v_mfma_f32_16x16x32_bf16 v[184:187], a[120:123], a[24:27], v[184:187]
    v_exp_f32 v81, v81
    v_fma_f32 v82, v82, s38, -v4
    v_exp_f32 v82, v82
    v_mfma_f32_16x16x32_bf16 v[184:187], a[124:127], a[28:31], v[184:187]
    v_fma_f32 v83, v83, s38, -v4
    v_exp_f32 v83, v83
    v_cvt_pk_bf16_f32 v72, v72, v73
    v_cvt_pk_bf16_f32 v73, v74, v75
    v_mfma_f32_16x16x32_bf16 v[192:195], a[96:99], a[32:35], 0
    v_cvt_pk_bf16_f32 v80, v80, v81
    v_cvt_pk_bf16_f32 v81, v82, v83
    v_fma_f32 v68, v68, s38, -v2
    v_exp_f32 v68, v68
    v_mfma_f32_16x16x32_bf16 v[192:195], a[100:103], a[36:39], v[192:195]
    v_fma_f32 v69, v69, s38, -v2
    v_exp_f32 v69, v69
    v_fma_f32 v70, v70, s38, -v2
    v_fma_f32 v71, v71, s38, -v2
    v_mfma_f32_16x16x32_bf16 v[192:195], a[104:107], a[40:43], v[192:195]
    v_exp_f32 v70, v70
    v_exp_f32 v71, v71
    v_fma_f32 v76, v76, s38, -v3
    v_mfma_f32_16x16x32_bf16 v[192:195], a[108:111], a[44:47], v[192:195]
    v_exp_f32 v76, v76
    v_fma_f32 v77, v77, s38, -v3
    v_exp_f32 v77, v77
    v_mfma_f32_16x16x32_bf16 v[192:195], a[112:115], a[48:51], v[192:195]
    v_fma_f32 v78, v78, s38, -v3
    v_exp_f32 v78, v78
    v_fma_f32 v79, v79, s38, -v3
    v_cvt_pk_bf16_f32 v66, v68, v69
    v_mfma_f32_16x16x32_bf16 v[192:195], a[116:119], a[52:55], v[192:195]
    v_exp_f32 v79, v79
    v_cvt_pk_bf16_f32 v67, v70, v71
    v_fma_f32 v84, v84, s38, -v4
    v_fma_f32 v85, v85, s38, -v4
    v_mfma_f32_16x16x32_bf16 v[192:195], a[120:123], a[56:59], v[192:195]
    v_exp_f32 v84, v84
    v_exp_f32 v85, v85
    v_fma_f32 v86, v86, s38, -v4
    v_mfma_f32_16x16x32_bf16 v[192:195], a[124:127], a[60:63], v[192:195]
    v_exp_f32 v86, v86
    v_fma_f32 v87, v87, s38, -v4
    v_exp_f32 v87, v87
    s_waitcnt vmcnt(9) lgkmcnt(0)
    s_barrier
    v_mfma_f32_16x16x32_bf16 v[200:203], a[96:99], a[64:67], 0
    s_add_u32 s4, s34, 57344
    s_add_u32 m0, s33, 16384
    ds_read_b128 a[128:131], v20 offset:40960
    ds_read_b128 a[132:135], v21 offset:40960
    v_mfma_f32_16x16x32_bf16 v[200:203], a[100:103], a[68:71], v[200:203]
    buffer_load_dwordx4 v16, s[16:19], s4 offen offset:0 nt lds
    v_mfma_f32_16x16x32_bf16 v[200:203], a[104:107], a[72:75], v[200:203]
    ds_read_b128 a[136:139], v22 offset:40960
    ds_read_b128 a[140:143], v23 offset:40960
    v_mfma_f32_16x16x32_bf16 v[200:203], a[108:111], a[76:79], v[200:203]
    buffer_load_dwordx4 v17, s[16:19], s4 offen offset:1024 nt lds
    v_mfma_f32_16x16x32_bf16 v[200:203], a[112:115], a[80:83], v[200:203]
    ds_read_b128 a[144:147], v20 offset:41216
    ds_read_b128 a[148:151], v21 offset:41216
    v_mfma_f32_16x16x32_bf16 v[200:203], a[116:119], a[84:87], v[200:203]
    buffer_load_dwordx4 v18, s[16:19], s4 offen offset:2048 nt lds
    v_mfma_f32_16x16x32_bf16 v[200:203], a[120:123], a[88:91], v[200:203]
    ds_read_b128 a[152:155], v22 offset:41216
    ds_read_b128 a[156:159], v23 offset:41216
    v_mfma_f32_16x16x32_bf16 v[200:203], a[124:127], a[92:95], v[200:203]
    s_waitcnt lgkmcnt(6)
    buffer_load_dwordx4 v19, s[16:19], s4 offen offset:3072 nt lds
    v_mfma_f32_16x16x32_bf16 v[188:191], a[128:131], a[0:3], 0
    v_cvt_pk_bf16_f32 v74, v76, v77
    v_cvt_pk_bf16_f32 v75, v78, v79
    v_cvt_pk_bf16_f32 v82, v84, v85
    v_cvt_pk_bf16_f32 v83, v86, v87
    v_fma_f32 v88, v88, s38, -v2
    v_mfma_f32_16x16x32_bf16 v[188:191], a[132:135], a[4:7], v[188:191]
    s_waitcnt lgkmcnt(4)
    v_exp_f32 v88, v88
    v_fma_f32 v89, v89, s38, -v2
    v_exp_f32 v89, v89
    v_mfma_f32_16x16x32_bf16 v[188:191], a[136:139], a[8:11], v[188:191]
    v_fma_f32 v90, v90, s38, -v2
    v_exp_f32 v90, v90
    v_fma_f32 v91, v91, s38, -v2
    v_fma_f32 v96, v96, s38, -v3
    v_mfma_f32_16x16x32_bf16 v[188:191], a[140:143], a[12:15], v[188:191]
    s_waitcnt lgkmcnt(2)
    v_exp_f32 v91, v91
    v_exp_f32 v96, v96
    v_fma_f32 v97, v97, s38, -v3
    v_mfma_f32_16x16x32_bf16 v[188:191], a[144:147], a[16:19], v[188:191]
    v_exp_f32 v97, v97
    v_fma_f32 v98, v98, s38, -v3
    v_exp_f32 v98, v98
    v_mfma_f32_16x16x32_bf16 v[188:191], a[148:151], a[20:23], v[188:191]
    s_waitcnt lgkmcnt(0)
    v_fma_f32 v99, v99, s38, -v3
    v_exp_f32 v99, v99
    v_cvt_pk_bf16_f32 v88, v88, v89
    v_cvt_pk_bf16_f32 v89, v90, v91
    v_mfma_f32_16x16x32_bf16 v[188:191], a[152:155], a[24:27], v[188:191]
    v_fma_f32 v104, v104, s38, -v4
    v_exp_f32 v104, v104
    v_fma_f32 v105, v105, s38, -v4
    v_fma_f32 v106, v106, s38, -v4
    v_mfma_f32_16x16x32_bf16 v[188:191], a[156:159], a[28:31], v[188:191]
    v_exp_f32 v105, v105
    v_exp_f32 v106, v106
    v_fma_f32 v107, v107, s38, -v4
    v_mfma_f32_16x16x32_bf16 v[196:199], a[128:131], a[32:35], 0
    v_exp_f32 v107, v107
    v_cvt_pk_bf16_f32 v96, v96, v97
    v_cvt_pk_bf16_f32 v97, v98, v99
    v_cvt_pk_bf16_f32 v104, v104, v105
    v_mfma_f32_16x16x32_bf16 v[196:199], a[132:135], a[36:39], v[196:199]
    v_cvt_pk_bf16_f32 v105, v106, v107
    v_fma_f32 v92, v92, s38, -v2
    v_exp_f32 v92, v92
    v_fma_f32 v93, v93, s38, -v2
    v_mfma_f32_16x16x32_bf16 v[196:199], a[136:139], a[40:43], v[196:199]
    v_exp_f32 v93, v93
    v_fma_f32 v94, v94, s38, -v2
    v_exp_f32 v94, v94
    v_mfma_f32_16x16x32_bf16 v[196:199], a[140:143], a[44:47], v[196:199]
    v_fma_f32 v95, v95, s38, -v2
    v_exp_f32 v95, v95
    v_fma_f32 v100, v100, s38, -v3
    v_fma_f32 v101, v101, s38, -v3
    v_mfma_f32_16x16x32_bf16 v[196:199], a[144:147], a[48:51], v[196:199]
    v_exp_f32 v100, v100
    v_exp_f32 v101, v101
    v_fma_f32 v102, v102, s38, -v3
    v_mfma_f32_16x16x32_bf16 v[196:199], a[148:151], a[52:55], v[196:199]
    v_exp_f32 v102, v102
    v_fma_f32 v103, v103, s38, -v3
    v_exp_f32 v103, v103
    v_mfma_f32_16x16x32_bf16 v[196:199], a[152:155], a[56:59], v[196:199]
    v_cvt_pk_bf16_f32 v90, v92, v93
    v_cvt_pk_bf16_f32 v91, v94, v95
    v_fma_f32 v108, v108, s38, -v4
    v_exp_f32 v108, v108
    v_mfma_f32_16x16x32_bf16 v[196:199], a[156:159], a[60:63], v[196:199]
    v_fma_f32 v109, v109, s38, -v4
    v_exp_f32 v109, v109
    v_fma_f32 v110, v110, s38, -v4
    v_fma_f32 v111, v111, s38, -v4
    s_waitcnt vmcnt(9) lgkmcnt(0)
    s_barrier
    v_mfma_f32_16x16x32_bf16 v[204:207], a[128:131], a[64:67], 0
    s_add_u32 s8, s34, 61440
    s_add_u32 m0, s33, 24576
    ds_read_b128 a[96:99], v20 offset:0
    ds_read_b128 a[100:103], v21 offset:0
    v_mfma_f32_16x16x32_bf16 v[204:207], a[132:135], a[68:71], v[204:207]
    buffer_load_dwordx4 v16, s[16:19], s8 offen offset:0 nt lds
    v_mfma_f32_16x16x32_bf16 v[204:207], a[136:139], a[72:75], v[204:207]
    ds_read_b128 a[104:107], v22 offset:0
    ds_read_b128 a[108:111], v23 offset:0
    v_mfma_f32_16x16x32_bf16 v[204:207], a[140:143], a[76:79], v[204:207]
    buffer_load_dwordx4 v17, s[16:19], s8 offen offset:1024 nt lds
    v_mfma_f32_16x16x32_bf16 v[204:207], a[144:147], a[80:83], v[204:207]
    ds_read_b128 a[112:115], v20 offset:256
    ds_read_b128 a[116:119], v21 offset:256
    v_mfma_f32_16x16x32_bf16 v[204:207], a[148:151], a[84:87], v[204:207]
    buffer_load_dwordx4 v18, s[16:19], s8 offen offset:2048 nt lds
    v_mfma_f32_16x16x32_bf16 v[204:207], a[152:155], a[88:91], v[204:207]
    ds_read_b128 a[120:123], v22 offset:256
    ds_read_b128 a[124:127], v23 offset:256
    v_mfma_f32_16x16x32_bf16 v[204:207], a[156:159], a[92:95], v[204:207]
    s_waitcnt lgkmcnt(6)
    buffer_load_dwordx4 v19, s[16:19], s8 offen offset:3072 nt lds
    v_mfma_f32_16x16x32_bf16 v[208:211], a[96:99], a[0:3], 0
    v_exp_f32 v110, v110
    v_exp_f32 v111, v111
    v_cvt_pk_bf16_f32 v98, v100, v101
    v_mfma_f32_16x16x32_bf16 v[208:211], a[100:103], a[4:7], v[208:211]
    s_waitcnt lgkmcnt(4)
    v_cvt_pk_bf16_f32 v99, v102, v103
    v_cvt_pk_bf16_f32 v106, v108, v109
    v_cvt_pk_bf16_f32 v107, v110, v111
    v_fma_f32 v112, v112, s38, -v2
    v_fma_f32 v113, v113, s38, -v2
    v_mfma_f32_16x16x32_bf16 v[208:211], a[104:107], a[8:11], v[208:211]
    v_exp_f32 v112, v112
    v_exp_f32 v113, v113
    v_fma_f32 v114, v114, s38, -v2
    v_mfma_f32_16x16x32_bf16 v[208:211], a[108:111], a[12:15], v[208:211]
    s_waitcnt lgkmcnt(2)
    v_exp_f32 v114, v114
    v_fma_f32 v115, v115, s38, -v2
    v_exp_f32 v115, v115
    v_mfma_f32_16x16x32_bf16 v[208:211], a[112:115], a[16:19], v[208:211]
    v_fma_f32 v120, v120, s38, -v3
    v_exp_f32 v120, v120
    v_fma_f32 v121, v121, s38, -v3
    v_fma_f32 v122, v122, s38, -v3
    v_mfma_f32_16x16x32_bf16 v[208:211], a[116:119], a[20:23], v[208:211]
    s_waitcnt lgkmcnt(0)
    v_exp_f32 v121, v121
    v_exp_f32 v122, v122
    v_fma_f32 v123, v123, s38, -v3
    v_mfma_f32_16x16x32_bf16 v[208:211], a[120:123], a[24:27], v[208:211]
    v_exp_f32 v123, v123
    v_cvt_pk_bf16_f32 v112, v112, v113
    v_cvt_pk_bf16_f32 v113, v114, v115
    v_fma_f32 v128, v128, s38, -v4
    v_mfma_f32_16x16x32_bf16 v[208:211], a[124:127], a[28:31], v[208:211]
    v_exp_f32 v128, v128
    v_fma_f32 v129, v129, s38, -v4
    v_exp_f32 v129, v129
    v_mfma_f32_16x16x32_bf16 v[216:219], a[96:99], a[32:35], 0
    v_fma_f32 v130, v130, s38, -v4
    v_exp_f32 v130, v130
    v_fma_f32 v131, v131, s38, -v4
    v_cvt_pk_bf16_f32 v120, v120, v121
    v_mfma_f32_16x16x32_bf16 v[216:219], a[100:103], a[36:39], v[216:219]
    v_exp_f32 v131, v131
    v_cvt_pk_bf16_f32 v121, v122, v123
    v_cvt_pk_bf16_f32 v128, v128, v129
    v_cvt_pk_bf16_f32 v129, v130, v131
    v_mfma_f32_16x16x32_bf16 v[216:219], a[104:107], a[40:43], v[216:219]
    v_fma_f32 v116, v116, s38, -v2
    v_exp_f32 v116, v116
    v_fma_f32 v117, v117, s38, -v2
    v_fma_f32 v118, v118, s38, -v2
    v_mfma_f32_16x16x32_bf16 v[216:219], a[108:111], a[44:47], v[216:219]
    v_exp_f32 v117, v117
    v_exp_f32 v118, v118
    v_fma_f32 v119, v119, s38, -v2
    v_mfma_f32_16x16x32_bf16 v[216:219], a[112:115], a[48:51], v[216:219]
    v_exp_f32 v119, v119
    v_fma_f32 v124, v124, s38, -v3
    v_exp_f32 v124, v124
    v_mfma_f32_16x16x32_bf16 v[216:219], a[116:119], a[52:55], v[216:219]
    v_fma_f32 v125, v125, s38, -v3
    v_exp_f32 v125, v125
    v_fma_f32 v126, v126, s38, -v3
    v_fma_f32 v127, v127, s38, -v3
    v_mfma_f32_16x16x32_bf16 v[216:219], a[120:123], a[56:59], v[216:219]
    v_exp_f32 v126, v126
    v_exp_f32 v127, v127
    v_cvt_pk_bf16_f32 v114, v116, v117
    v_mfma_f32_16x16x32_bf16 v[216:219], a[124:127], a[60:63], v[216:219]
    v_cvt_pk_bf16_f32 v115, v118, v119
    v_fma_f32 v132, v132, s38, -v4
    v_exp_f32 v132, v132
    v_fma_f32 v133, v133, s38, -v4
    s_waitcnt vmcnt(8) lgkmcnt(0)
    s_barrier
    v_mfma_f32_16x16x32_bf16 v[224:227], a[96:99], a[64:67], 0
    s_add_u32 s4, s52, 32768
    s_add_u32 m0, s33, 32768
    ds_read_b128 a[128:131], v20 offset:8192
    ds_read_b128 a[132:135], v21 offset:8192
    v_mfma_f32_16x16x32_bf16 v[224:227], a[100:103], a[68:71], v[224:227]
    buffer_load_dwordx4 v6, s[20:23], s4 offen offset:0 nt lds
    v_mfma_f32_16x16x32_bf16 v[224:227], a[104:107], a[72:75], v[224:227]
    s_add_u32 s5, s52, 97280
    ds_read_b128 a[136:139], v22 offset:8192
    ds_read_b128 a[140:143], v23 offset:8192
    v_mfma_f32_16x16x32_bf16 v[224:227], a[108:111], a[76:79], v[224:227]
    buffer_load_dwordx4 v6, s[20:23], s5 offen offset:1024 nt lds
    v_mfma_f32_16x16x32_bf16 v[224:227], a[112:115], a[80:83], v[224:227]
    s_add_u32 s6, s52, 34816
    ds_read_b128 a[144:147], v20 offset:8448
    ds_read_b128 a[148:151], v21 offset:8448
    v_mfma_f32_16x16x32_bf16 v[224:227], a[116:119], a[84:87], v[224:227]
    buffer_load_dwordx4 v6, s[20:23], s6 offen offset:2048 nt lds
    v_mfma_f32_16x16x32_bf16 v[224:227], a[120:123], a[88:91], v[224:227]
    s_add_u32 s7, s52, 99328
    ds_read_b128 a[152:155], v22 offset:8448
    ds_read_b128 a[156:159], v23 offset:8448
    v_mfma_f32_16x16x32_bf16 v[224:227], a[124:127], a[92:95], v[224:227]
    s_waitcnt lgkmcnt(6)
    buffer_load_dwordx4 v6, s[20:23], s7 offen offset:3072 nt lds
    v_mfma_f32_16x16x32_bf16 v[212:215], a[128:131], a[0:3], 0
    v_exp_f32 v133, v133
    v_fma_f32 v134, v134, s38, -v4
    v_exp_f32 v134, v134
    v_mfma_f32_16x16x32_bf16 v[212:215], a[132:135], a[4:7], v[212:215]
    s_waitcnt lgkmcnt(4)
    v_fma_f32 v135, v135, s38, -v4
    v_exp_f32 v135, v135
    v_cvt_pk_bf16_f32 v122, v124, v125
    v_cvt_pk_bf16_f32 v123, v126, v127
    v_mfma_f32_16x16x32_bf16 v[212:215], a[136:139], a[8:11], v[212:215]
    v_cvt_pk_bf16_f32 v130, v132, v133
    v_cvt_pk_bf16_f32 v131, v134, v135
    v_fma_f32 v136, v136, s38, -v2
    v_exp_f32 v136, v136
    v_mfma_f32_16x16x32_bf16 v[212:215], a[140:143], a[12:15], v[212:215]
    s_waitcnt lgkmcnt(2)
    v_fma_f32 v137, v137, s38, -v2
    v_exp_f32 v137, v137
    v_fma_f32 v138, v138, s38, -v2
    v_fma_f32 v139, v139, s38, -v2
    v_mfma_f32_16x16x32_bf16 v[212:215], a[144:147], a[16:19], v[212:215]
    v_exp_f32 v138, v138
    v_exp_f32 v139, v139
    v_fma_f32 v144, v144, s38, -v3
    v_mfma_f32_16x16x32_bf16 v[212:215], a[148:151], a[20:23], v[212:215]
    s_waitcnt lgkmcnt(0)
    v_exp_f32 v144, v144
    v_fma_f32 v145, v145, s38, -v3
    v_exp_f32 v145, v145
    v_mfma_f32_16x16x32_bf16 v[212:215], a[152:155], a[24:27], v[212:215]
    v_fma_f32 v146, v146, s38, -v3
    v_exp_f32 v146, v146
    v_fma_f32 v147, v147, s38, -v3
    v_cvt_pk_bf16_f32 v136, v136, v137
    v_mfma_f32_16x16x32_bf16 v[212:215], a[156:159], a[28:31], v[212:215]
    v_exp_f32 v147, v147
    v_cvt_pk_bf16_f32 v137, v138, v139
    v_fma_f32 v152, v152, s38, -v4
    v_fma_f32 v153, v153, s38, -v4
    v_mfma_f32_16x16x32_bf16 v[220:223], a[128:131], a[32:35], 0
    v_exp_f32 v152, v152
    v_exp_f32 v153, v153
    v_fma_f32 v154, v154, s38, -v4
    v_mfma_f32_16x16x32_bf16 v[220:223], a[132:135], a[36:39], v[220:223]
    v_exp_f32 v154, v154
    v_fma_f32 v155, v155, s38, -v4
    v_exp_f32 v155, v155
    v_mfma_f32_16x16x32_bf16 v[220:223], a[136:139], a[40:43], v[220:223]
    v_cvt_pk_bf16_f32 v144, v144, v145
    v_cvt_pk_bf16_f32 v145, v146, v147
    v_cvt_pk_bf16_f32 v152, v152, v153
    v_cvt_pk_bf16_f32 v153, v154, v155
    v_fma_f32 v140, v140, s38, -v2
    v_mfma_f32_16x16x32_bf16 v[220:223], a[140:143], a[44:47], v[220:223]
    v_exp_f32 v140, v140
    v_fma_f32 v141, v141, s38, -v2
    v_exp_f32 v141, v141
    v_mfma_f32_16x16x32_bf16 v[220:223], a[144:147], a[48:51], v[220:223]
    v_fma_f32 v142, v142, s38, -v2
    v_exp_f32 v142, v142
    v_fma_f32 v143, v143, s38, -v2
    v_fma_f32 v148, v148, s38, -v3
    v_mfma_f32_16x16x32_bf16 v[220:223], a[148:151], a[52:55], v[220:223]
    v_exp_f32 v143, v143
    v_exp_f32 v148, v148
    v_fma_f32 v149, v149, s38, -v3
    v_mfma_f32_16x16x32_bf16 v[220:223], a[152:155], a[56:59], v[220:223]
    v_exp_f32 v149, v149
    v_fma_f32 v150, v150, s38, -v3
    v_exp_f32 v150, v150
    v_mfma_f32_16x16x32_bf16 v[220:223], a[156:159], a[60:63], v[220:223]
    v_fma_f32 v151, v151, s38, -v3
    v_exp_f32 v151, v151
    v_cvt_pk_bf16_f32 v138, v140, v141
    v_cvt_pk_bf16_f32 v139, v142, v143
    v_readfirstlane_b32 s47, v34
    s_nop 1
    s_cmp_lg_u32 s47, s43
    s_cbranch_scc1 L_ack_spin
L_ack_ok:
    v_readfirstlane_b32 s48, v35
    s_cmp_eq_u32 s47, s43
    s_nop 0
    s_cselect_b32 s48, s48, -1
    s_cmp_eq_u32 s48, s35
    s_cselect_b32 s36, 1, 0
    s_waitcnt vmcnt(8) lgkmcnt(0)
    s_barrier
    v_mfma_f32_16x16x32_bf16 v[228:231], a[128:131], a[64:67], 0
    s_add_u32 s8, s52, 49152
    s_add_u32 m0, s33, 40960
    ds_read_b128 a[96:99], v20 offset:16384
    ds_read_b128 a[100:103], v21 offset:16384
    v_mfma_f32_16x16x32_bf16 v[228:231], a[132:135], a[68:71], v[228:231]
    buffer_load_dwordx4 v6, s[20:23], s8 offen offset:0 nt lds
    v_mfma_f32_16x16x32_bf16 v[228:231], a[136:139], a[72:75], v[228:231]
    s_add_u32 s9, s52, 113664
    ds_read_b128 a[104:107], v22 offset:16384
    ds_read_b128 a[108:111], v23 offset:16384
    v_mfma_f32_16x16x32_bf16 v[228:231], a[140:143], a[76:79], v[228:231]
    buffer_load_dwordx4 v6, s[20:23], s9 offen offset:1024 nt lds
    v_mfma_f32_16x16x32_bf16 v[228:231], a[144:147], a[80:83], v[228:231]
    s_add_u32 s10, s52, 51200
    ds_read_b128 a[112:115], v20 offset:16640
    ds_read_b128 a[116:119], v21 offset:16640
    v_mfma_f32_16x16x32_bf16 v[228:231], a[148:151], a[84:87], v[228:231]
    buffer_load_dwordx4 v6, s[20:23], s10 offen offset:2048 nt lds
    v_mfma_f32_16x16x32_bf16 v[228:231], a[152:155], a[88:91], v[228:231]
    s_add_u32 s11, s52, 115712
    ds_read_b128 a[120:123], v22 offset:16640
    ds_read_b128 a[124:127], v23 offset:16640
    v_mfma_f32_16x16x32_bf16 v[228:231], a[156:159], a[92:95], v[228:231]
    s_waitcnt lgkmcnt(6)
    buffer_load_dwordx4 v6, s[20:23], s11 offen offset:3072 nt lds
    v_mfma_f32_16x16x32_bf16 v[232:235], a[96:99], a[0:3], 0
    v_fma_f32 v156, v156, s38, -v4
    v_exp_f32 v156, v156
    v_fma_f32 v157, v157, s38, -v4
    v_fma_f32 v158, v158, s38, -v4
    v_mfma_f32_16x16x32_bf16 v[232:235], a[100:103], a[4:7], v[232:235]
    s_waitcnt lgkmcnt(4)
    v_exp_f32 v157, v157
    v_exp_f32 v158, v158
    v_fma_f32 v159, v159, s38, -v4
    v_mfma_f32_16x16x32_bf16 v[232:235], a[104:107], a[8:11], v[232:235]
    v_exp_f32 v159, v159
    v_cvt_pk_bf16_f32 v146, v148, v149
    v_cvt_pk_bf16_f32 v147, v150, v151
    v_cvt_pk_bf16_f32 v154, v156, v157
    v_mfma_f32_16x16x32_bf16 v[232:235], a[108:111], a[12:15], v[232:235]
    s_waitcnt lgkmcnt(2)
    v_cvt_pk_bf16_f32 v155, v158, v159
    v_fma_f32 v160, v160, s38, -v2
    v_exp_f32 v160, v160
    v_fma_f32 v161, v161, s38, -v2
    v_mfma_f32_16x16x32_bf16 v[232:235], a[112:115], a[16:19], v[232:235]
    v_exp_f32 v161, v161
    v_fma_f32 v162, v162, s38, -v2
    v_exp_f32 v162, v162
    v_mfma_f32_16x16x32_bf16 v[232:235], a[116:119], a[20:23], v[232:235]
    s_waitcnt lgkmcnt(0)
    v_fma_f32 v163, v163, s38, -v2
    v_exp_f32 v163, v163
    v_fma_f32 v168, v168, s38, -v3
    v_fma_f32 v169, v169, s38, -v3
    v_mfma_f32_16x16x32_bf16 v[232:235], a[120:123], a[24:27], v[232:235]
    v_exp_f32 v168, v168
    v_exp_f32 v169, v169
    v_fma_f32 v170, v170, s38, -v3
    v_mfma_f32_16x16x32_bf16 v[232:235], a[124:127], a[28:31], v[232:235]
    v_exp_f32 v170, v170
    v_fma_f32 v171, v171, s38, -v3
    v_exp_f32 v171, v171
    v_mfma_f32_16x16x32_bf16 v[240:243], a[96:99], a[32:35], 0
    v_cvt_pk_bf16_f32 v160, v160, v161
    v_cvt_pk_bf16_f32 v161, v162, v163
    v_fma_f32 v176, v176, s38, -v4
    v_exp_f32 v176, v176
    v_mfma_f32_16x16x32_bf16 v[240:243], a[100:103], a[36:39], v[240:243]
    v_fma_f32 v177, v177, s38, -v4
    v_exp_f32 v177, v177
    v_fma_f32 v178, v178, s38, -v4
    v_fma_f32 v179, v179, s38, -v4
    v_mfma_f32_16x16x32_bf16 v[240:243], a[104:107], a[40:43], v[240:243]
    v_exp_f32 v178, v178
    v_exp_f32 v179, v179
    v_cvt_pk_bf16_f32 v168, v168, v169
    v_mfma_f32_16x16x32_bf16 v[240:243], a[108:111], a[44:47], v[240:243]
    v_cvt_pk_bf16_f32 v169, v170, v171
    v_cvt_pk_bf16_f32 v176, v176, v177
    v_cvt_pk_bf16_f32 v177, v178, v179
    v_fma_f32 v164, v164, s38, -v2
    v_fma_f32 v165, v165, s38, -v2
    v_mfma_f32_16x16x32_bf16 v[240:243], a[112:115], a[48:51], v[240:243]
    v_exp_f32 v164, v164
    v_exp_f32 v165, v165
    v_fma_f32 v166, v166, s38, -v2
    v_mfma_f32_16x16x32_bf16 v[240:243], a[116:119], a[52:55], v[240:243]
    v_exp_f32 v166, v166
    v_fma_f32 v167, v167, s38, -v2
    v_exp_f32 v167, v167
    v_mfma_f32_16x16x32_bf16 v[240:243], a[120:123], a[56:59], v[240:243]
    v_fma_f32 v172, v172, s38, -v3
    v_exp_f32 v172, v172
    v_fma_f32 v173, v173, s38, -v3
    v_fma_f32 v174, v174, s38, -v3
    v_mfma_f32_16x16x32_bf16 v[240:243], a[124:127], a[60:63], v[240:243]
    v_exp_f32 v173, v173
    v_exp_f32 v174, v174
    v_fma_f32 v175, v175, s38, -v3
    s_waitcnt vmcnt(8) lgkmcnt(0)
    s_barrier
    v_mfma_f32_16x16x32_bf16 v[248:251], a[96:99], a[64:67], 0
    s_add_u32 s4, s53, 0
    s_add_u32 m0, s33, 0
    ds_read_b128 a[128:131], v20 offset:24576
    ds_read_b128 a[132:135], v21 offset:24576
    v_mfma_f32_16x16x32_bf16 v[248:251], a[100:103], a[68:71], v[248:251]
    buffer_load_dwordx4 v6, s[20:23], s4 offen offset:0 nt lds
    v_mfma_f32_16x16x32_bf16 v[248:251], a[104:107], a[72:75], v[248:251]
    s_add_u32 s5, s53, 64512
    ds_read_b128 a[136:139], v22 offset:24576
    ds_read_b128 a[140:143], v23 offset:24576
    v_mfma_f32_16x16x32_bf16 v[248:251], a[108:111], a[76:79], v[248:251]
    buffer_load_dwordx4 v6, s[20:23], s5 offen offset:1024 nt lds
    v_mfma_f32_16x16x32_bf16 v[248:251], a[112:115], a[80:83], v[248:251]
    s_add_u32 s6, s53, 2048
    ds_read_b128 a[144:147], v20 offset:24832
    ds_read_b128 a[148:151], v21 offset:24832
    v_mfma_f32_16x16x32_bf16 v[248:251], a[116:119], a[84:87], v[248:251]
    buffer_load_dwordx4 v6, s[20:23], s6 offen offset:2048 nt lds
    v_mfma_f32_16x16x32_bf16 v[248:251], a[120:123], a[88:91], v[248:251]
    s_add_u32 s7, s53, 66560
    ds_read_b128 a[152:155], v22 offset:24832
    ds_read_b128 a[156:159], v23 offset:24832
    v_mfma_f32_16x16x32_bf16 v[248:251], a[124:127], a[92:95], v[248:251]
    s_waitcnt lgkmcnt(6)
    buffer_load_dwordx4 v6, s[20:23], s7 offen offset:3072 nt lds
    v_mfma_f32_16x16x32_bf16 v[236:239], a[128:131], a[0:3], 0
    v_exp_f32 v175, v175
    v_cvt_pk_bf16_f32 v162, v164, v165
    v_cvt_pk_bf16_f32 v163, v166, v167
    v_fma_f32 v180, v180, s38, -v4
    v_mfma_f32_16x16x32_bf16 v[236:239], a[132:135], a[4:7], v[236:239]
    s_waitcnt lgkmcnt(4)
    v_exp_f32 v180, v180
    v_fma_f32 v181, v181, s38, -v4
    v_exp_f32 v181, v181
    v_mfma_f32_16x16x32_bf16 v[236:239], a[136:139], a[8:11], v[236:239]
    v_fma_f32 v182, v182, s38, -v4
    v_exp_f32 v182, v182
    v_fma_f32 v183, v183, s38, -v4
    v_cvt_pk_bf16_f32 v170, v172, v173
    v_mfma_f32_16x16x32_bf16 v[236:239], a[140:143], a[12:15], v[236:239]
    s_waitcnt lgkmcnt(2)
    v_exp_f32 v183, v183
    v_cvt_pk_bf16_f32 v171, v174, v175
    v_cvt_pk_bf16_f32 v178, v180, v181
    v_cvt_pk_bf16_f32 v179, v182, v183
    v_mfma_f32_16x16x32_bf16 v[236:239], a[144:147], a[16:19], v[236:239]
    v_fma_f32 v184, v184, s38, -v2
    v_exp_f32 v184, v184
    v_fma_f32 v185, v185, s38, -v2
    v_fma_f32 v186, v186, s38, -v2
    v_mfma_f32_16x16x32_bf16 v[236:239], a[148:151], a[20:23], v[236:239]
    s_waitcnt lgkmcnt(0)
    v_exp_f32 v185, v185
    v_exp_f32 v186, v186
    v_fma_f32 v187, v187, s38, -v2
    v_mfma_f32_16x16x32_bf16 v[236:239], a[152:155], a[24:27], v[236:239]
    v_exp_f32 v187, v187
    v_fma_f32 v192, v192, s38, -v3
    v_exp_f32 v192, v192
    v_mfma_f32_16x16x32_bf16 v[236:239], a[156:159], a[28:31], v[236:239]
    v_fma_f32 v193, v193, s38, -v3
    v_exp_f32 v193, v193
    v_fma_f32 v194, v194, s38, -v3
    v_fma_f32 v195, v195, s38, -v3
    v_mfma_f32_16x16x32_bf16 v[244:247], a[128:131], a[32:35], 0
    v_exp_f32 v194, v194
    v_exp_f32 v195, v195
    v_cvt_pk_bf16_f32 v184, v184, v185
    v_mfma_f32_16x16x32_bf16 v[244:247], a[132:135], a[36:39], v[244:247]
    v_cvt_pk_bf16_f32 v185, v186, v187
    v_fma_f32 v200, v200, s38, -v4
    v_exp_f32 v200, v200
    v_fma_f32 v201, v201, s38, -v4
    v_mfma_f32_16x16x32_bf16 v[244:247], a[136:139], a[40:43], v[244:247]
    v_exp_f32 v201, v201
    v_fma_f32 v202, v202, s38, -v4
    v_exp_f32 v202, v202
    v_mfma_f32_16x16x32_bf16 v[244:247], a[140:143], a[44:47], v[244:247]
    v_fma_f32 v203, v203, s38, -v4
    v_exp_f32 v203, v203
    v_cvt_pk_bf16_f32 v192, v192, v193
    v_cvt_pk_bf16_f32 v193, v194, v195
    v_mfma_f32_16x16x32_bf16 v[244:247], a[144:147], a[48:51], v[244:247]
    v_cvt_pk_bf16_f32 v200, v200, v201
    v_cvt_pk_bf16_f32 v201, v202, v203
    v_fma_f32 v188, v188, s38, -v2
    v_exp_f32 v188, v188
    v_mfma_f32_16x16x32_bf16 v[244:247], a[148:151], a[52:55], v[244:247]
    v_fma_f32 v189, v189, s38, -v2
    v_exp_f32 v189, v189
    v_fma_f32 v190, v190, s38, -v2
    v_fma_f32 v191, v191, s38, -v2
    v_mfma_f32_16x16x32_bf16 v[244:247], a[152:155], a[56:59], v[244:247]
    v_exp_f32 v190, v190
    v_exp_f32 v191, v191
    v_fma_f32 v196, v196, s38, -v3
    v_mfma_f32_16x16x32_bf16 v[244:247], a[156:159], a[60:63], v[244:247]
    v_exp_f32 v196, v196
    v_fma_f32 v197, v197, s38, -v3
    v_exp_f32 v197, v197
    s_barrier
    v_mfma_f32_16x16x32_bf16 v[252:255], a[128:131], a[64:67], 0
    s_add_u32 s8, s53, 16384
    s_add_u32 m0, s33, 8192
    ds_read_b64_tr_b16 a[192:193], v44 offset:0
    ds_read_b64_tr_b16 a[194:195], v44 offset:2048
    v_mfma_f32_16x16x32_bf16 v[252:255], a[132:135], a[68:71], v[252:255]
    buffer_load_dwordx4 v6, s[20:23], s8 offen offset:0 nt lds
    v_mfma_f32_16x16x32_bf16 v[252:255], a[136:139], a[72:75], v[252:255]
    s_add_u32 s9, s53, 80896
    ds_read_b64_tr_b16 a[196:197], v45 offset:0
    ds_read_b64_tr_b16 a[198:199], v45 offset:2048
    v_mfma_f32_16x16x32_bf16 v[252:255], a[140:143], a[76:79], v[252:255]
    buffer_load_dwordx4 v6, s[20:23], s9 offen offset:1024 nt lds
    v_mfma_f32_16x16x32_bf16 v[252:255], a[144:147], a[80:83], v[252:255]
    s_add_u32 s10, s53, 18432
    ds_read_b64_tr_b16 a[200:201], v46 offset:0
    ds_read_b64_tr_b16 a[202:203], v46 offset:2048
    v_mfma_f32_16x16x32_bf16 v[252:255], a[148:151], a[84:87], v[252:255]
    buffer_load_dwordx4 v6, s[20:23], s10 offen offset:2048 nt lds
    v_mfma_f32_16x16x32_bf16 v[252:255], a[152:155], a[88:91], v[252:255]
    s_add_u32 s11, s53, 82944
    ds_read_b64_tr_b16 a[204:205], v47 offset:0
    ds_read_b64_tr_b16 a[206:207], v47 offset:2048
    v_mfma_f32_16x16x32_bf16 v[252:255], a[156:159], a[92:95], v[252:255]
    buffer_load_dwordx4 v6, s[20:23], s11 offen offset:3072 nt lds
    v_mfma_f32_16x16x32_bf16 a[176:179], a[160:163], v[64:67], 0
    ds_read_b64_tr_b16 a[208:209], v44 offset:4096
    v_fma_f32 v198, v198, s38, -v3
    v_fma_f32 v199, v199, s38, -v3
    v_cvt_pk_bf16_f32 v186, v188, v189
    v_mfma_f32_16x16x32_bf16 a[180:183], a[160:163], v[72:75], 0
    ds_read_b64_tr_b16 a[210:211], v44 offset:6144
    v_exp_f32 v198, v198
    v_mfma_f32_16x16x32_bf16 a[184:187], a[160:163], v[80:83], 0
    s_waitcnt lgkmcnt(8)
    ds_read_b64_tr_b16 a[212:213], v45 offset:4096
    v_exp_f32 v199, v199
    v_cvt_pk_bf16_f32 v187, v190, v191
    v_mfma_f32_16x16x32_bf16 a[0:3], a[192:195], v[64:67], 0
    ds_read_b64_tr_b16 a[214:215], v45 offset:6144
    v_fma_f32 v204, v204, s38, -v4
    v_fma_f32 v205, v205, s38, -v4
    v_mfma_f32_16x16x32_bf16 a[4:7], a[192:195], v[72:75], 0
    ds_read_b64_tr_b16 a[216:217], v46 offset:4096
    v_exp_f32 v204, v204
    v_fma_f32 v206, v206, s38, -v4
    v_mfma_f32_16x16x32_bf16 a[8:11], a[192:195], v[80:83], 0
    s_waitcnt lgkmcnt(9)
    ds_read_b64_tr_b16 a[218:219], v46 offset:6144
    v_exp_f32 v205, v205
    v_mfma_f32_16x16x32_bf16 a[12:15], a[196:199], v[64:67], 0
    ds_read_b64_tr_b16 a[220:221], v47 offset:4096
    v_exp_f32 v206, v206
    v_fma_f32 v207, v207, s38, -v4
    v_mfma_f32_16x16x32_bf16 a[16:19], a[196:199], v[72:75], 0
    ds_read_b64_tr_b16 a[222:223], v47 offset:6144
    v_exp_f32 v207, v207
    v_mfma_f32_16x16x32_bf16 a[20:23], a[196:199], v[80:83], 0
    s_waitcnt lgkmcnt(10)
    v_cvt_pk_bf16_f32 v194, v196, v197
    v_cvt_pk_bf16_f32 v195, v198, v199
    v_cvt_pk_bf16_f32 v202, v204, v205
    v_cvt_pk_bf16_f32 v203, v206, v207
    v_mfma_f32_16x16x32_bf16 a[24:27], a[200:203], v[64:67], 0
    v_fma_f32 v208, v208, s38, -v2
    v_exp_f32 v208, v208
    v_mfma_f32_16x16x32_bf16 a[28:31], a[200:203], v[72:75], 0
    v_fma_f32 v209, v209, s38, -v2
    v_exp_f32 v209, v209
    v_fma_f32 v210, v210, s38, -v2
    v_mfma_f32_16x16x32_bf16 a[32:35], a[200:203], v[80:83], 0
    s_waitcnt lgkmcnt(8)
    v_exp_f32 v210, v210
    v_fma_f32 v211, v211, s38, -v2
    v_mfma_f32_16x16x32_bf16 a[36:39], a[204:207], v[64:67], 0
    v_exp_f32 v211, v211
    v_fma_f32 v216, v216, s38, -v3
    v_fma_f32 v217, v217, s38, -v3
    v_mfma_f32_16x16x32_bf16 a[40:43], a[204:207], v[72:75], 0
    v_exp_f32 v216, v216
    v_fma_f32 v218, v218, s38, -v3
    v_mfma_f32_16x16x32_bf16 a[44:47], a[204:207], v[80:83], 0
    v_exp_f32 v217, v217
    v_fma_f32 v219, v219, s38, -v3
    v_cvt_pk_bf16_f32 v208, v208, v209
    v_mfma_f32_16x16x32_bf16 a[176:179], a[160:163], v[88:91], a[176:179]
    v_exp_f32 v218, v218
    v_cvt_pk_bf16_f32 v209, v210, v211
    v_fma_f32 v224, v224, s38, -v4
    v_mfma_f32_16x16x32_bf16 a[180:183], a[160:163], v[96:99], a[180:183]
    v_exp_f32 v219, v219
    v_fma_f32 v225, v225, s38, -v4
    v_mfma_f32_16x16x32_bf16 a[184:187], a[160:163], v[104:107], a[184:187]
    s_waitcnt lgkmcnt(6)
    v_exp_f32 v224, v224
    v_fma_f32 v226, v226, s38, -v4
    v_fma_f32 v227, v227, s38, -v4
    v_mfma_f32_16x16x32_bf16 a[0:3], a[208:211], v[88:91], a[0:3]
    v_exp_f32 v225, v225
    v_cvt_pk_bf16_f32 v216, v216, v217
    v_mfma_f32_16x16x32_bf16 a[4:7], a[208:211], v[96:99], a[4:7]
    v_exp_f32 v226, v226
    v_cvt_pk_bf16_f32 v217, v218, v219
    v_cvt_pk_bf16_f32 v224, v224, v225
    v_mfma_f32_16x16x32_bf16 a[8:11], a[208:211], v[104:107], a[8:11]
    s_waitcnt lgkmcnt(4)
    v_exp_f32 v227, v227
    v_fma_f32 v212, v212, s38, -v2
    v_mfma_f32_16x16x32_bf16 a[12:15], a[212:215], v[88:91], a[12:15]
    v_exp_f32 v212, v212
    v_cvt_pk_bf16_f32 v225, v226, v227
    v_fma_f32 v213, v213, s38, -v2
    v_mfma_f32_16x16x32_bf16 a[16:19], a[212:215], v[96:99], a[16:19]
    v_exp_f32 v213, v213
    v_fma_f32 v214, v214, s38, -v2
    v_mfma_f32_16x16x32_bf16 a[20:23], a[212:215], v[104:107], a[20:23]
    v_exp_f32 v214, v214
    v_fma_f32 v215, v215, s38, -v2
    v_fma_f32 v220, v220, s38, -v3
    s_waitcnt vmcnt(41) lgkmcnt(0)
    s_barrier
    v_mfma_f32_16x16x32_bf16 a[24:27], a[216:219], v[88:91], a[24:27]
    s_add_u32 s4, s53, 32768
    s_add_u32 m0, s33, 16384
    ds_read_b64_tr_b16 a[224:225], v44 offset:8192
    ds_read_b64_tr_b16 a[226:227], v44 offset:10240
    v_mfma_f32_16x16x32_bf16 a[28:31], a[216:219], v[96:99], a[28:31]
    buffer_load_dwordx4 v6, s[20:23], s4 offen offset:0 nt lds
    v_mfma_f32_16x16x32_bf16 a[32:35], a[216:219], v[104:107], a[32:35]
    s_add_u32 s5, s53, 97280
    ds_read_b64_tr_b16 a[228:229], v45 offset:8192
    ds_read_b64_tr_b16 a[230:231], v45 offset:10240
    v_mfma_f32_16x16x32_bf16 a[36:39], a[220:223], v[88:91], a[36:39]
    buffer_load_dwordx4 v6, s[20:23], s5 offen offset:1024 nt lds
    v_mfma_f32_16x16x32_bf16 a[40:43], a[220:223], v[96:99], a[40:43]
    s_add_u32 s6, s53, 34816
    ds_read_b64_tr_b16 a[232:233], v46 offset:8192
    ds_read_b64_tr_b16 a[234:235], v46 offset:10240
    v_mfma_f32_16x16x32_bf16 a[44:47], a[220:223], v[104:107], a[44:47]
    buffer_load_dwordx4 v6, s[20:23], s6 offen offset:2048 nt lds
    v_mfma_f32_16x16x32_bf16 a[176:179], a[160:163], v[112:115], a[176:179]
    s_add_u32 s7, s53, 99328
    ds_read_b64_tr_b16 a[236:237], v47 offset:8192
    ds_read_b64_tr_b16 a[238:239], v47 offset:10240
    v_mfma_f32_16x16x32_bf16 a[180:183], a[160:163], v[120:123], a[180:183]
    buffer_load_dwordx4 v6, s[20:23], s7 offen offset:3072 nt lds
    v_mfma_f32_16x16x32_bf16 a[184:187], a[160:163], v[128:131], a[184:187]
    s_waitcnt lgkmcnt(6)
    ds_read_b64_tr_b16 a[240:241], v44 offset:12288
    v_exp_f32 v215, v215
    v_fma_f32 v221, v221, s38, -v3
    v_mfma_f32_16x16x32_bf16 a[0:3], a[224:227], v[112:115], a[0:3]
    ds_read_b64_tr_b16 a[242:243], v44 offset:14336
    v_exp_f32 v220, v220
    v_mfma_f32_16x16x32_bf16 a[4:7], a[224:227], v[120:123], a[4:7]
    ds_read_b64_tr_b16 a[244:245], v45 offset:12288
    v_exp_f32 v221, v221
    v_fma_f32 v222, v222, s38, -v3
    v_mfma_f32_16x16x32_bf16 a[8:11], a[224:227], v[128:131], a[8:11]
    s_waitcnt lgkmcnt(7)
    ds_read_b64_tr_b16 a[246:247], v45 offset:14336
    v_exp_f32 v222, v222
    v_mfma_f32_16x16x32_bf16 a[12:15], a[228:231], v[112:115], a[12:15]
    ds_read_b64_tr_b16 a[248:249], v46 offset:12288
    v_fma_f32 v223, v223, s38, -v3
    v_cvt_pk_bf16_f32 v210, v212, v213
    v_cvt_pk_bf16_f32 v211, v214, v215
    v_mfma_f32_16x16x32_bf16 a[16:19], a[228:231], v[120:123], a[16:19]
    ds_read_b64_tr_b16 a[250:251], v46 offset:14336
    v_exp_f32 v223, v223
    v_mfma_f32_16x16x32_bf16 a[20:23], a[228:231], v[128:131], a[20:23]
    s_waitcnt lgkmcnt(8)
    ds_read_b64_tr_b16 a[252:253], v47 offset:12288
    v_fma_f32 v228, v228, s38, -v4
    v_fma_f32 v229, v229, s38, -v4
    v_fma_f32 v230, v230, s38, -v4
    v_mfma_f32_16x16x32_bf16 a[24:27], a[232:235], v[112:115], a[24:27]
    ds_read_b64_tr_b16 a[254:255], v47 offset:14336
    v_exp_f32 v228, v228
    v_mfma_f32_16x16x32_bf16 a[28:31], a[232:235], v[120:123], a[28:31]
    v_exp_f32 v229, v229
    v_fma_f32 v231, v231, s38, -v4
    v_cvt_pk_bf16_f32 v218, v220, v221
    v_mfma_f32_16x16x32_bf16 a[32:35], a[232:235], v[128:131], a[32:35]
    s_waitcnt lgkmcnt(8)
    v_exp_f32 v230, v230
    v_cvt_pk_bf16_f32 v219, v222, v223
    v_mfma_f32_16x16x32_bf16 a[36:39], a[236:239], v[112:115], a[36:39]
    v_exp_f32 v231, v231
    v_cvt_pk_bf16_f32 v226, v228, v229
    v_cvt_pk_bf16_f32 v227, v230, v231
    v_mfma_f32_16x16x32_bf16 a[40:43], a[236:239], v[120:123], a[40:43]
    v_fma_f32 v232, v232, s38, -v2
    v_exp_f32 v232, v232
    v_mfma_f32_16x16x32_bf16 a[44:47], a[236:239], v[128:131], a[44:47]
    v_fma_f32 v233, v233, s38, -v2
    v_exp_f32 v233, v233
    v_fma_f32 v234, v234, s38, -v2
    v_mfma_f32_16x16x32_bf16 a[176:179], a[160:163], v[136:139], a[176:179]
    v_exp_f32 v234, v234
    v_fma_f32 v235, v235, s38, -v2
    v_fma_f32 v240, v240, s38, -v3
    v_mfma_f32_16x16x32_bf16 a[180:183], a[160:163], v[144:147], a[180:183]
    v_exp_f32 v235, v235
    v_fma_f32 v241, v241, s38, -v3
    v_mfma_f32_16x16x32_bf16 a[184:187], a[160:163], v[152:155], a[184:187]
    s_waitcnt lgkmcnt(6)
    v_exp_f32 v240, v240
    v_fma_f32 v242, v242, s38, -v3
    v_fma_f32 v243, v243, s38, -v3
    v_mfma_f32_16x16x32_bf16 a[0:3], a[240:243], v[136:139], a[0:3]
    v_exp_f32 v241, v241
    v_cvt_pk_bf16_f32 v232, v232, v233
    v_mfma_f32_16x16x32_bf16 a[4:7], a[240:243], v[144:147], a[4:7]
    v_exp_f32 v242, v242
    v_cvt_pk_bf16_f32 v233, v234, v235
    v_fma_f32 v248, v248, s38, -v4
    v_mfma_f32_16x16x32_bf16 a[8:11], a[240:243], v[152:155], a[8:11]
    s_waitcnt lgkmcnt(4)
    v_exp_f32 v243, v243
    v_fma_f32 v249, v249, s38, -v4
    v_mfma_f32_16x16x32_bf16 a[12:15], a[244:247], v[136:139], a[12:15]
    v_exp_f32 v248, v248
    v_fma_f32 v250, v250, s38, -v4
    v_fma_f32 v251, v251, s38, -v4
    v_mfma_f32_16x16x32_bf16 a[16:19], a[244:247], v[144:147], a[16:19]
    v_exp_f32 v249, v249
    v_cvt_pk_bf16_f32 v240, v240, v241
    v_mfma_f32_16x16x32_bf16 a[20:23], a[244:247], v[152:155], a[20:23]
    v_exp_f32 v250, v250
    v_cvt_pk_bf16_f32 v241, v242, v243
    v_cvt_pk_bf16_f32 v248, v248, v249
    s_waitcnt vmcnt(16) lgkmcnt(0)
    s_barrier
    v_mfma_f32_16x16x32_bf16 a[24:27], a[248:251], v[136:139], a[24:27]
    s_add_u32 s8, s53, 49152
    s_add_u32 m0, s33, 24576
    ds_read_b64_tr_b16 a[192:193], v8 offset:32768
    ds_read_b64_tr_b16 a[194:195], v8 offset:34816
    v_mfma_f32_16x16x32_bf16 a[28:31], a[248:251], v[144:147], a[28:31]
    buffer_load_dwordx4 v6, s[20:23], s8 offen offset:0 nt lds
    v_mfma_f32_16x16x32_bf16 a[32:35], a[248:251], v[152:155], a[32:35]
    s_add_u32 s9, s53, 113664
    ds_read_b64_tr_b16 a[196:197], v9 offset:32768
    ds_read_b64_tr_b16 a[198:199], v9 offset:34816
    v_mfma_f32_16x16x32_bf16 a[36:39], a[252:255], v[136:139], a[36:39]
    buffer_load_dwordx4 v6, s[20:23], s9 offen offset:1024 nt lds
    v_mfma_f32_16x16x32_bf16 a[40:43], a[252:255], v[144:147], a[40:43]
    s_add_u32 s10, s53, 51200
    ds_read_b64_tr_b16 a[200:201], v10 offset:32768
    ds_read_b64_tr_b16 a[202:203], v10 offset:34816
    v_mfma_f32_16x16x32_bf16 a[44:47], a[252:255], v[152:155], a[44:47]
    buffer_load_dwordx4 v6, s[20:23], s10 offen offset:2048 nt lds
    v_mfma_f32_16x16x32_bf16 a[176:179], a[160:163], v[160:163], a[176:179]
    s_add_u32 s11, s53, 115712
    ds_read_b64_tr_b16 a[204:205], v11 offset:32768
    ds_read_b64_tr_b16 a[206:207], v11 offset:34816
    v_mfma_f32_16x16x32_bf16 a[180:183], a[160:163], v[168:171], a[180:183]
    buffer_load_dwordx4 v6, s[20:23], s11 offen offset:3072 nt lds
    v_mfma_f32_16x16x32_bf16 a[184:187], a[160:163], v[176:179], a[184:187]
    s_waitcnt lgkmcnt(6)
    ds_read_b64_tr_b16 a[208:209], v8 offset:36864
    v_exp_f32 v251, v251
    v_fma_f32 v236, v236, s38, -v2
    v_mfma_f32_16x16x32_bf16 a[0:3], a[192:195], v[160:163], a[0:3]
    ds_read_b64_tr_b16 a[210:211], v8 offset:38912
    v_exp_f32 v236, v236
    v_mfma_f32_16x16x32_bf16 a[4:7], a[192:195], v[168:171], a[4:7]
    ds_read_b64_tr_b16 a[212:213], v9 offset:36864
    v_cvt_pk_bf16_f32 v249, v250, v251
    v_fma_f32 v237, v237, s38, -v2
    v_fma_f32 v238, v238, s38, -v2
    v_mfma_f32_16x16x32_bf16 a[8:11], a[192:195], v[176:179], a[8:11]
    s_waitcnt lgkmcnt(7)
    ds_read_b64_tr_b16 a[214:215], v9 offset:38912
    v_exp_f32 v237, v237
    v_mfma_f32_16x16x32_bf16 a[12:15], a[196:199], v[160:163], a[12:15]
    ds_read_b64_tr_b16 a[216:217], v10 offset:36864
    v_exp_f32 v238, v238
    v_fma_f32 v239, v239, s38, -v2
    v_mfma_f32_16x16x32_bf16 a[16:19], a[196:199], v[168:171], a[16:19]
    ds_read_b64_tr_b16 a[218:219], v10 offset:38912
    v_exp_f32 v239, v239
    v_mfma_f32_16x16x32_bf16 a[20:23], a[196:199], v[176:179], a[20:23]
    s_waitcnt lgkmcnt(8)
    ds_read_b64_tr_b16 a[220:221], v11 offset:36864
    v_fma_f32 v244, v244, s38, -v3
    v_fma_f32 v245, v245, s38, -v3
    v_fma_f32 v246, v246, s38, -v3
    v_mfma_f32_16x16x32_bf16 a[24:27], a[200:203], v[160:163], a[24:27]
    ds_read_b64_tr_b16 a[222:223], v11 offset:38912
    v_exp_f32 v244, v244
    v_mfma_f32_16x16x32_bf16 a[28:31], a[200:203], v[168:171], a[28:31]
    v_exp_f32 v245, v245
    v_fma_f32 v247, v247, s38, -v3
    v_cvt_pk_bf16_f32 v234, v236, v237
    v_mfma_f32_16x16x32_bf16 a[32:35], a[200:203], v[176:179], a[32:35]
    s_waitcnt lgkmcnt(8)
    v_exp_f32 v246, v246
    v_cvt_pk_bf16_f32 v235, v238, v239
    v_mfma_f32_16x16x32_bf16 a[36:39], a[204:207], v[160:163], a[36:39]
    v_exp_f32 v247, v247
    v_fma_f32 v252, v252, s38, -v4
    v_fma_f32 v253, v253, s38, -v4
    v_mfma_f32_16x16x32_bf16 a[40:43], a[204:207], v[168:171], a[40:43]
    v_exp_f32 v252, v252
    v_fma_f32 v254, v254, s38, -v4
    v_mfma_f32_16x16x32_bf16 a[44:47], a[204:207], v[176:179], a[44:47]
    v_exp_f32 v253, v253
    v_fma_f32 v255, v255, s38, -v4
    v_cvt_pk_bf16_f32 v242, v244, v245
    v_mfma_f32_16x16x32_bf16 a[176:179], a[160:163], v[184:187], a[176:179]
    v_exp_f32 v254, v254
    v_cvt_pk_bf16_f32 v243, v246, v247
    v_cvt_pk_bf16_f32 v250, v252, v253
    v_mfma_f32_16x16x32_bf16 a[180:183], a[160:163], v[192:195], a[180:183]
    v_exp_f32 v255, v255
    s_nop 0
    v_cvt_pk_bf16_f32 v251, v254, v255
    v_mfma_f32_16x16x32_bf16 a[184:187], a[160:163], v[200:203], a[184:187]
    s_waitcnt lgkmcnt(6)
    v_mfma_f32_16x16x32_bf16 a[0:3], a[208:211], v[184:187], a[0:3]
    v_mfma_f32_16x16x32_bf16 a[4:7], a[208:211], v[192:195], a[4:7]
    v_mfma_f32_16x16x32_bf16 a[8:11], a[208:211], v[200:203], a[8:11]
    s_waitcnt lgkmcnt(4)
    v_mfma_f32_16x16x32_bf16 a[12:15], a[212:215], v[184:187], a[12:15]
    v_mfma_f32_16x16x32_bf16 a[16:19], a[212:215], v[192:195], a[16:19]
    v_mfma_f32_16x16x32_bf16 a[20:23], a[212:215], v[200:203], a[20:23]
    s_waitcnt vmcnt(16) lgkmcnt(0)
    s_barrier
    v_mfma_f32_16x16x32_bf16 a[24:27], a[216:219], v[184:187], a[24:27]
    s_add_u32 s4, s54, 0
    s_add_u32 m0, s33, 32768
    ds_read_b64_tr_b16 a[224:225], v8 offset:40960
    ds_read_b64_tr_b16 a[226:227], v8 offset:43008
    v_mfma_f32_16x16x32_bf16 a[28:31], a[216:219], v[192:195], a[28:31]
    buffer_load_dwordx4 v6, s[20:23], s4 offen offset:0 nt lds
    v_mfma_f32_16x16x32_bf16 a[32:35], a[216:219], v[200:203], a[32:35]
    s_add_u32 s5, s54, 64512
    ds_read_b64_tr_b16 a[228:229], v9 offset:40960
    ds_read_b64_tr_b16 a[230:231], v9 offset:43008
    v_mfma_f32_16x16x32_bf16 a[36:39], a[220:223], v[184:187], a[36:39]
    buffer_load_dwordx4 v6, s[20:23], s5 offen offset:1024 nt lds
    v_mfma_f32_16x16x32_bf16 a[40:43], a[220:223], v[192:195], a[40:43]
    s_add_u32 s6, s54, 2048
    ds_read_b64_tr_b16 a[232:233], v10 offset:40960
    ds_read_b64_tr_b16 a[234:235], v10 offset:43008
    v_mfma_f32_16x16x32_bf16 a[44:47], a[220:223], v[200:203], a[44:47]
    buffer_load_dwordx4 v6, s[20:23], s6 offen offset:2048 nt lds
    v_mfma_f32_16x16x32_bf16 a[176:179], a[160:163], v[208:211], a[176:179]
    s_add_u32 s7, s54, 66560
    ds_read_b64_tr_b16 a[236:237], v11 offset:40960
    ds_read_b64_tr_b16 a[238:239], v11 offset:43008
    v_mfma_f32_16x16x32_bf16 a[180:183], a[160:163], v[216:219], a[180:183]
    buffer_load_dwordx4 v6, s[20:23], s7 offen offset:3072 nt lds
    v_mfma_f32_16x16x32_bf16 a[184:187], a[160:163], v[224:227], a[184:187]
    s_waitcnt lgkmcnt(6)
    ds_read_b64_tr_b16 a[240:241], v8 offset:45056
    v_mfma_f32_16x16x32_bf16 a[0:3], a[224:227], v[208:211], a[0:3]
    ds_read_b64_tr_b16 a[242:243], v8 offset:47104
    v_mfma_f32_16x16x32_bf16 a[4:7], a[224:227], v[216:219], a[4:7]
    ds_read_b64_tr_b16 a[244:245], v9 offset:45056
    v_mfma_f32_16x16x32_bf16 a[8:11], a[224:227], v[224:227], a[8:11]
    s_waitcnt lgkmcnt(7)
    ds_read_b64_tr_b16 a[246:247], v9 offset:47104
    v_mfma_f32_16x16x32_bf16 a[12:15], a[228:231], v[208:211], a[12:15]
    ds_read_b64_tr_b16 a[248:249], v10 offset:45056
    v_mfma_f32_16x16x32_bf16 a[16:19], a[228:231], v[216:219], a[16:19]
    ds_read_b64_tr_b16 a[250:251], v10 offset:47104
    v_mfma_f32_16x16x32_bf16 a[20:23], a[228:231], v[224:227], a[20:23]
    s_waitcnt lgkmcnt(8)
    ds_read_b64_tr_b16 a[252:253], v11 offset:45056
    v_mfma_f32_16x16x32_bf16 a[24:27], a[232:235], v[208:211], a[24:27]
    ds_read_b64_tr_b16 a[254:255], v11 offset:47104
    v_mfma_f32_16x16x32_bf16 a[28:31], a[232:235], v[216:219], a[28:31]
    v_mfma_f32_16x16x32_bf16 a[32:35], a[232:235], v[224:227], a[32:35]
    s_waitcnt lgkmcnt(8)
    v_mfma_f32_16x16x32_bf16 a[36:39], a[236:239], v[208:211], a[36:39]
    v_mfma_f32_16x16x32_bf16 a[40:43], a[236:239], v[216:219], a[40:43]
    v_mfma_f32_16x16x32_bf16 a[44:47], a[236:239], v[224:227], a[44:47]
    v_mfma_f32_16x16x32_bf16 a[176:179], a[160:163], v[232:235], a[176:179]
    v_mfma_f32_16x16x32_bf16 a[180:183], a[160:163], v[240:243], a[180:183]
    v_mfma_f32_16x16x32_bf16 a[184:187], a[160:163], v[248:251], a[184:187]
    s_waitcnt lgkmcnt(6)
    v_mfma_f32_16x16x32_bf16 a[0:3], a[240:243], v[232:235], a[0:3]
    v_mfma_f32_16x16x32_bf16 a[4:7], a[240:243], v[240:243], a[4:7]
    v_mfma_f32_16x16x32_bf16 a[8:11], a[240:243], v[248:251], a[8:11]
    s_waitcnt lgkmcnt(4)
    v_mfma_f32_16x16x32_bf16 a[12:15], a[244:247], v[232:235], a[12:15]
    v_mfma_f32_16x16x32_bf16 a[16:19], a[244:247], v[240:243], a[16:19]
    v_mfma_f32_16x16x32_bf16 a[20:23], a[244:247], v[248:251], a[20:23]
    s_waitcnt vmcnt(16) lgkmcnt(0)
    s_barrier
    v_mfma_f32_16x16x32_bf16 a[24:27], a[248:251], v[232:235], a[24:27]
    ds_read_b64_tr_b16 a[192:193], v8 offset:0
    ds_read_b64_tr_b16 a[194:195], v8 offset:2048
    v_mfma_f32_16x16x32_bf16 a[28:31], a[248:251], v[240:243], a[28:31]
    ds_read_b64_tr_b16 a[196:197], v9 offset:0
    ds_read_b64_tr_b16 a[198:199], v9 offset:2048
    v_mfma_f32_16x16x32_bf16 a[32:35], a[248:251], v[248:251], a[32:35]
    ds_read_b64_tr_b16 a[200:201], v10 offset:0
    ds_read_b64_tr_b16 a[202:203], v10 offset:2048
    v_mfma_f32_16x16x32_bf16 a[36:39], a[252:255], v[232:235], a[36:39]
    ds_read_b64_tr_b16 a[204:205], v11 offset:0
    ds_read_b64_tr_b16 a[206:207], v11 offset:2048
    v_mfma_f32_16x16x32_bf16 a[40:43], a[252:255], v[240:243], a[40:43]
    ds_read_b64_tr_b16 a[208:209], v8 offset:4096
    ds_read_b64_tr_b16 a[210:211], v8 offset:6144
    v_mfma_f32_16x16x32_bf16 a[44:47], a[252:255], v[248:251], a[44:47]
    s_waitcnt lgkmcnt(8)
    ds_read_b64_tr_b16 a[212:213], v9 offset:4096
    ds_read_b64_tr_b16 a[214:215], v9 offset:6144
    v_mfma_f32_16x16x32_bf16 v[16:19], a[192:195], v[64:67], 0
    ds_read_b64_tr_b16 a[216:217], v10 offset:4096
    ds_read_b64_tr_b16 a[218:219], v10 offset:6144
    v_mfma_f32_16x16x32_bf16 v[20:23], a[192:195], v[72:75], 0
    ds_read_b64_tr_b16 a[220:221], v11 offset:4096
    ds_read_b64_tr_b16 a[222:223], v11 offset:6144
    v_mfma_f32_16x16x32_bf16 v[24:27], a[192:195], v[80:83], 0
    s_waitcnt lgkmcnt(12)
    ds_write_b32 v7, a176 offset:1024
    v_mfma_f32_16x16x32_bf16 v[28:31], a[196:199], v[64:67], 0
    ds_write_b32 v7, a180 offset:1028
    v_mfma_f32_16x16x32_bf16 v[32:35], a[196:199], v[72:75], 0
    ds_write_b32 v7, a184 offset:1032
    v_mfma_f32_16x16x32_bf16 v[36:39], a[196:199], v[80:83], 0
    s_waitcnt lgkmcnt(13)
    s_add_u32 s8, s54, 16384
    s_add_u32 m0, s33, 40960
    ds_write_b128 v0, a[0:3] offset:0
    v_mfma_f32_16x16x32_bf16 v[40:43], a[200:203], v[64:67], 0
    buffer_load_dwordx4 v6, s[20:23], s8 offen offset:0 nt lds
    v_mfma_f32_16x16x32_bf16 v[44:47], a[200:203], v[72:75], 0
    v_mfma_f32_16x16x32_bf16 v[48:51], a[200:203], v[80:83], 0
    s_waitcnt lgkmcnt(12)
    s_add_u32 s9, s54, 80896
    ds_write_b128 v0, a[4:7] offset:1024
    v_mfma_f32_16x16x32_bf16 v[52:55], a[204:207], v[64:67], 0
    buffer_load_dwordx4 v6, s[20:23], s9 offen offset:1024 nt lds
    v_mfma_f32_16x16x32_bf16 v[56:59], a[204:207], v[72:75], 0
    v_mfma_f32_16x16x32_bf16 v[60:63], a[204:207], v[80:83], 0
    s_waitcnt lgkmcnt(11)
    s_add_u32 s10, s54, 18432
    ds_write_b128 v0, a[8:11] offset:2048
    v_mfma_f32_16x16x32_bf16 v[16:19], a[208:211], v[88:91], v[16:19]
    buffer_load_dwordx4 v6, s[20:23], s10 offen offset:2048 nt lds
    v_mfma_f32_16x16x32_bf16 v[20:23], a[208:211], v[96:99], v[20:23]
    v_mfma_f32_16x16x32_bf16 v[24:27], a[208:211], v[104:107], v[24:27]
    s_waitcnt lgkmcnt(10)
    s_add_u32 s11, s54, 82944
    ds_write_b128 v0, a[12:15] offset:3072
    v_mfma_f32_16x16x32_bf16 v[28:31], a[212:215], v[88:91], v[28:31]
    buffer_load_dwordx4 v6, s[20:23], s11 offen offset:3072 nt lds
    v_mfma_f32_16x16x32_bf16 v[32:35], a[212:215], v[96:99], v[32:35]
    v_mfma_f32_16x16x32_bf16 v[36:39], a[212:215], v[104:107], v[36:39]
    s_waitcnt vmcnt(16) lgkmcnt(0)
    s_barrier
    v_mfma_f32_16x16x32_bf16 v[40:43], a[216:219], v[88:91], v[40:43]
    ds_read_b64_tr_b16 a[224:225], v8 offset:8192
    ds_read_b64_tr_b16 a[226:227], v8 offset:10240
    v_mfma_f32_16x16x32_bf16 v[44:47], a[216:219], v[96:99], v[44:47]
    ds_read_b64_tr_b16 a[228:229], v9 offset:8192
    ds_read_b64_tr_b16 a[230:231], v9 offset:10240
    v_mfma_f32_16x16x32_bf16 v[48:51], a[216:219], v[104:107], v[48:51]
    ds_read_b64_tr_b16 a[232:233], v10 offset:8192
    ds_read_b64_tr_b16 a[234:235], v10 offset:10240
    v_mfma_f32_16x16x32_bf16 v[52:55], a[220:223], v[88:91], v[52:55]
    ds_read_b64_tr_b16 a[236:237], v11 offset:8192
    ds_read_b64_tr_b16 a[238:239], v11 offset:10240
    v_mfma_f32_16x16x32_bf16 v[56:59], a[220:223], v[96:99], v[56:59]
    ds_read_b64_tr_b16 a[240:241], v8 offset:12288
    ds_read_b64_tr_b16 a[242:243], v8 offset:14336
    v_mfma_f32_16x16x32_bf16 v[60:63], a[220:223], v[104:107], v[60:63]
    s_waitcnt lgkmcnt(8)
    ds_read_b64_tr_b16 a[244:245], v9 offset:12288
    ds_read_b64_tr_b16 a[246:247], v9 offset:14336
    v_mfma_f32_16x16x32_bf16 v[16:19], a[224:227], v[112:115], v[16:19]
    ds_read_b64_tr_b16 a[248:249], v10 offset:12288
    ds_read_b64_tr_b16 a[250:251], v10 offset:14336
    v_mfma_f32_16x16x32_bf16 v[20:23], a[224:227], v[120:123], v[20:23]
    ds_read_b64_tr_b16 a[252:253], v11 offset:12288
    ds_read_b64_tr_b16 a[254:255], v11 offset:14336
    v_mfma_f32_16x16x32_bf16 v[24:27], a[224:227], v[128:131], v[24:27]
    s_waitcnt lgkmcnt(12)
    ds_read_b128 v[68:71], v1 offset:0
    ds_read_b128 v[76:79], v1 offset:1024
    v_mfma_f32_16x16x32_bf16 v[28:31], a[228:231], v[112:115], v[28:31]
    ds_read_b128 v[84:87], v1 offset:2048
    s_waitcnt lgkmcnt(11)
    ds_read_b128 v[92:95], v1 offset:3072
    v_mfma_f32_16x16x32_bf16 v[32:35], a[228:231], v[120:123], v[32:35]
    ds_read_b96 v[12:14], v15 offset:1024
    v_mfma_f32_16x16x32_bf16 v[36:39], a[228:231], v[128:131], v[36:39]
    s_add_u32 s4, s54, 32768
    s_add_u32 m0, s33, 0
    ds_write_b128 v0, a[16:19] offset:4096
    v_mfma_f32_16x16x32_bf16 v[40:43], a[232:235], v[112:115], v[40:43]
    buffer_load_dwordx4 v6, s[20:23], s4 offen offset:0 nt lds
    v_mfma_f32_16x16x32_bf16 v[44:47], a[232:235], v[120:123], v[44:47]
    v_mfma_f32_16x16x32_bf16 v[48:51], a[232:235], v[128:131], v[48:51]
    s_add_u32 s5, s54, 97280
    ds_write_b128 v0, a[20:23] offset:5120
    v_mfma_f32_16x16x32_bf16 v[52:55], a[236:239], v[112:115], v[52:55]
    buffer_load_dwordx4 v6, s[20:23], s5 offen offset:1024 nt lds
    v_mfma_f32_16x16x32_bf16 v[56:59], a[236:239], v[120:123], v[56:59]
    v_mfma_f32_16x16x32_bf16 v[60:63], a[236:239], v[128:131], v[60:63]
    s_waitcnt lgkmcnt(13)
    s_add_u32 s6, s54, 34816
    ds_write_b128 v0, a[24:27] offset:6144
    v_mfma_f32_16x16x32_bf16 v[16:19], a[240:243], v[136:139], v[16:19]
    buffer_load_dwordx4 v6, s[20:23], s6 offen offset:2048 nt lds
    v_mfma_f32_16x16x32_bf16 v[20:23], a[240:243], v[144:147], v[20:23]
    v_mfma_f32_16x16x32_bf16 v[24:27], a[240:243], v[152:155], v[24:27]
    s_waitcnt lgkmcnt(12)
    s_add_u32 s7, s54, 99328
    ds_write_b128 v0, a[28:31] offset:7168
    v_mfma_f32_16x16x32_bf16 v[28:31], a[244:247], v[136:139], v[28:31]
    buffer_load_dwordx4 v6, s[20:23], s7 offen offset:3072 nt lds
    v_mfma_f32_16x16x32_bf16 v[32:35], a[244:247], v[144:147], v[32:35]
    v_mfma_f32_16x16x32_bf16 v[36:39], a[244:247], v[152:155], v[36:39]
    s_waitcnt vmcnt(16) lgkmcnt(0)
    s_barrier
    v_mfma_f32_16x16x32_bf16 v[40:43], a[248:251], v[136:139], v[40:43]
    ds_read_b64_tr_b16 a[192:193], v8 offset:16384
    ds_read_b64_tr_b16 a[194:195], v8 offset:18432
    v_mfma_f32_16x16x32_bf16 v[44:47], a[248:251], v[144:147], v[44:47]
    ds_read_b64_tr_b16 a[196:197], v9 offset:16384
    ds_read_b64_tr_b16 a[198:199], v9 offset:18432
    v_mfma_f32_16x16x32_bf16 v[48:51], a[248:251], v[152:155], v[48:51]
    ds_read_b64_tr_b16 a[200:201], v10 offset:16384
    ds_read_b64_tr_b16 a[202:203], v10 offset:18432
    v_mfma_f32_16x16x32_bf16 v[52:55], a[252:255], v[136:139], v[52:55]
    ds_read_b64_tr_b16 a[204:205], v11 offset:16384
    ds_read_b64_tr_b16 a[206:207], v11 offset:18432
    v_mfma_f32_16x16x32_bf16 v[56:59], a[252:255], v[144:147], v[56:59]
    ds_read_b64_tr_b16 a[208:209], v8 offset:20480
    ds_read_b64_tr_b16 a[210:211], v8 offset:22528
    v_mfma_f32_16x16x32_bf16 v[60:63], a[252:255], v[152:155], v[60:63]
    s_waitcnt lgkmcnt(8)
    ds_read_b64_tr_b16 a[212:213], v9 offset:20480
    ds_read_b64_tr_b16 a[214:215], v9 offset:22528
    v_mfma_f32_16x16x32_bf16 v[16:19], a[192:195], v[160:163], v[16:19]
    ds_read_b64_tr_b16 a[216:217], v10 offset:20480
    ds_read_b64_tr_b16 a[218:219], v10 offset:22528
    v_mfma_f32_16x16x32_bf16 v[20:23], a[192:195], v[168:171], v[20:23]
    ds_read_b64_tr_b16 a[220:221], v11 offset:20480
    ds_read_b64_tr_b16 a[222:223], v11 offset:22528
    v_mfma_f32_16x16x32_bf16 v[24:27], a[192:195], v[176:179], v[24:27]
    s_waitcnt lgkmcnt(12)
    ds_read_b128 v[100:103], v1 offset:4096
    ds_read_b128 v[108:111], v1 offset:5120
    v_accvgpr_read_b32 v5, a176
    v_add_f32 v12, v12, v5
    v_mfma_f32_16x16x32_bf16 v[28:31], a[196:199], v[160:163], v[28:31]
    ds_read_b128 v[116:119], v1 offset:6144
    s_waitcnt lgkmcnt(11)
    ds_read_b128 v[124:127], v1 offset:7168
    v_accvgpr_read_b32 v5, a180
    v_add_f32 v13, v13, v5
    v_mfma_f32_16x16x32_bf16 v[32:35], a[196:199], v[168:171], v[32:35]
    v_accvgpr_read_b32 v5, a184
    v_add_f32 v14, v14, v5
    v_max3_f32 v212, v12, v13, v14
    v_mov_b32 v214, 155648
    v_mfma_f32_16x16x32_bf16 v[36:39], a[196:199], v[176:179], v[36:39]
    s_add_u32 s8, s54, 49152
    s_add_u32 m0, s33, 8192
    ds_write_b128 v0, a[32:35] offset:8192
    v_add_f32 v16, v16, v68
    v_add_f32 v17, v17, v69
    v_add_f32 v18, v18, v70
    v_add_f32 v19, v19, v71
    v_mfma_f32_16x16x32_bf16 v[40:43], a[200:203], v[160:163], v[40:43]
    buffer_load_dwordx4 v6, s[20:23], s8 offen offset:0 nt lds
    v_add_f32 v20, v20, v76
    v_add_f32 v21, v21, v77
    v_add_f32 v22, v22, v78
    v_add_f32 v23, v23, v79
    v_mfma_f32_16x16x32_bf16 v[44:47], a[200:203], v[168:171], v[44:47]
    v_add_f32 v24, v24, v84
    v_add_f32 v25, v25, v85
    v_add_f32 v26, v26, v86
    v_add_f32 v27, v27, v87
    v_mfma_f32_16x16x32_bf16 v[48:51], a[200:203], v[176:179], v[48:51]
    s_add_u32 s9, s54, 113664
    ds_write_b128 v0, a[36:39] offset:9216
    v_add_f32 v28, v28, v92
    v_add_f32 v29, v29, v93
    v_add_f32 v30, v30, v94
    v_add_f32 v31, v31, v95
    v_mfma_f32_16x16x32_bf16 v[52:55], a[204:207], v[160:163], v[52:55]
    buffer_load_dwordx4 v6, s[20:23], s9 offen offset:1024 nt lds
    v_mfma_f32_16x16x32_bf16 v[56:59], a[204:207], v[168:171], v[56:59]
    v_cmp_gt_f32 s[86:87], v212, s83
    s_lshl_b32 s48, s32, 2
    s_add_u32 s48, s48, 155648
    v_mov_b32 v212, s48
    v_mfma_f32_16x16x32_bf16 v[60:63], a[204:207], v[176:179], v[60:63]
    s_waitcnt lgkmcnt(12)
    s_add_u32 s10, s54, 51200
    ds_write_b128 v0, a[40:43] offset:10240
    v_mfma_f32_16x16x32_bf16 v[16:19], a[208:211], v[184:187], v[16:19]
    buffer_load_dwordx4 v6, s[20:23], s10 offen offset:2048 nt lds
    s_cmp_lg_u64 s[86:87], 0
    s_cselect_b32 s48, 1, 0
    v_mov_b32 v213, s48
    v_mfma_f32_16x16x32_bf16 v[20:23], a[208:211], v[192:195], v[20:23]
    ds_write_b32 v212, v213
    v_mfma_f32_16x16x32_bf16 v[24:27], a[208:211], v[200:203], v[24:27]
    s_waitcnt lgkmcnt(12)
    s_add_u32 s11, s54, 115712
    ds_write_b128 v0, a[44:47] offset:11264
    v_mfma_f32_16x16x32_bf16 v[28:31], a[212:215], v[184:187], v[28:31]
    buffer_load_dwordx4 v6, s[20:23], s11 offen offset:3072 nt lds
    v_mfma_f32_16x16x32_bf16 v[32:35], a[212:215], v[192:195], v[32:35]
    v_mfma_f32_16x16x32_bf16 v[36:39], a[212:215], v[200:203], v[36:39]
    s_waitcnt vmcnt(16) lgkmcnt(0)
    s_barrier
    v_mfma_f32_16x16x32_bf16 v[40:43], a[216:219], v[184:187], v[40:43]
    ds_read_b64_tr_b16 a[224:225], v8 offset:24576
    ds_read_b64_tr_b16 a[226:227], v8 offset:26624
    v_mfma_f32_16x16x32_bf16 v[44:47], a[216:219], v[192:195], v[44:47]
    ds_read_b64_tr_b16 a[228:229], v9 offset:24576
    ds_read_b64_tr_b16 a[230:231], v9 offset:26624
    v_mfma_f32_16x16x32_bf16 v[48:51], a[216:219], v[200:203], v[48:51]
    ds_read_b64_tr_b16 a[232:233], v10 offset:24576
    ds_read_b64_tr_b16 a[234:235], v10 offset:26624
    v_mfma_f32_16x16x32_bf16 v[52:55], a[220:223], v[184:187], v[52:55]
    ds_read_b64_tr_b16 a[236:237], v11 offset:24576
    ds_read_b64_tr_b16 a[238:239], v11 offset:26624
    v_mfma_f32_16x16x32_bf16 v[56:59], a[220:223], v[192:195], v[56:59]
    ds_read_b64_tr_b16 a[240:241], v8 offset:28672
    ds_read_b64_tr_b16 a[242:243], v8 offset:30720
    v_mfma_f32_16x16x32_bf16 v[60:63], a[220:223], v[200:203], v[60:63]
    s_waitcnt lgkmcnt(8)
    ds_read_b64_tr_b16 a[244:245], v9 offset:28672
    ds_read_b64_tr_b16 a[246:247], v9 offset:30720
    v_mfma_f32_16x16x32_bf16 v[16:19], a[224:227], v[208:211], v[16:19]
    ds_read_b64_tr_b16 a[248:249], v10 offset:28672
    ds_read_b64_tr_b16 a[250:251], v10 offset:30720
    v_mfma_f32_16x16x32_bf16 v[20:23], a[224:227], v[216:219], v[20:23]
    ds_read_b64_tr_b16 a[252:253], v11 offset:28672
    ds_read_b64_tr_b16 a[254:255], v11 offset:30720
    v_mfma_f32_16x16x32_bf16 v[24:27], a[224:227], v[224:227], v[24:27]
    s_waitcnt lgkmcnt(12)
    ds_read_b128 v[132:135], v1 offset:8192
    ds_read_b128 v[140:143], v1 offset:9216
    v_mbcnt_lo_u32_b32 v7, -1, 0
    v_mfma_f32_16x16x32_bf16 v[28:31], a[228:231], v[208:211], v[28:31]
    ds_read_b128 v[148:151], v1 offset:10240
    s_waitcnt lgkmcnt(11)
    ds_read_b128 v[156:159], v1 offset:11264
    v_mbcnt_hi_u32_b32 v7, -1, v7
    v_lshrrev_b32 v5, 3, v7
    v_mfma_f32_16x16x32_bf16 v[32:35], a[228:231], v[216:219], v[32:35]
    ds_read_b128 v[220:223], v214
    v_lshlrev_b32 v5, 5, v5
    v_and_or_b32 v5, v7, 7, v5
    v_mfma_f32_16x16x32_bf16 v[36:39], a[228:231], v[224:227], v[36:39]
    s_add_u32 s4, s55, 0
    s_add_u32 m0, s33, 16384
    v_lshlrev_b32 v5, 4, v5
    v_mfma_f32_16x16x32_bf16 v[40:43], a[232:235], v[208:211], v[40:43]
    buffer_load_dwordx4 v6, s[20:23], s4 offen offset:0 nt lds
    v_mfma_f32_16x16x32_bf16 v[44:47], a[232:235], v[216:219], v[44:47]
    v_mfma_f32_16x16x32_bf16 v[48:51], a[232:235], v[224:227], v[48:51]
    s_add_u32 s5, s55, 64512
    v_mfma_f32_16x16x32_bf16 v[52:55], a[236:239], v[208:211], v[52:55]
    buffer_load_dwordx4 v6, s[20:23], s5 offen offset:1024 nt lds
    v_add_f32 v32, v32, v100
    v_add_f32 v33, v33, v101
    v_add_f32 v34, v34, v102
    v_add_f32 v35, v35, v103
    v_mfma_f32_16x16x32_bf16 v[56:59], a[236:239], v[216:219], v[56:59]
    v_add_f32 v36, v36, v108
    v_add_f32 v37, v37, v109
    v_add_f32 v38, v38, v110
    v_add_f32 v39, v39, v111
    v_mfma_f32_16x16x32_bf16 v[60:63], a[236:239], v[224:227], v[60:63]
    s_waitcnt lgkmcnt(11)
    s_add_u32 s6, s55, 2048
    v_add_f32 v40, v40, v116
    v_add_f32 v41, v41, v117
    v_add_f32 v42, v42, v118
    v_add_f32 v43, v43, v119
    v_mfma_f32_16x16x32_bf16 v[16:19], a[240:243], v[232:235], v[16:19]
    buffer_load_dwordx4 v6, s[20:23], s6 offen offset:2048 nt lds
    v_add_f32 v44, v44, v124
    v_add_f32 v45, v45, v125
    v_add_f32 v46, v46, v126
    v_add_f32 v47, v47, v127
    v_mfma_f32_16x16x32_bf16 v[20:23], a[240:243], v[240:243], v[20:23]
    s_waitcnt lgkmcnt(3)
    v_add_f32 v48, v48, v132
    v_add_f32 v49, v49, v133
    v_add_f32 v50, v50, v134
    v_add_f32 v51, v51, v135
    v_mfma_f32_16x16x32_bf16 v[24:27], a[240:243], v[248:251], v[24:27]
    s_add_u32 s7, s55, 66560
    v_add_f32 v52, v52, v140
    v_add_f32 v53, v53, v141
    v_add_f32 v54, v54, v142
    v_add_f32 v55, v55, v143
    v_mfma_f32_16x16x32_bf16 v[28:31], a[244:247], v[232:235], v[28:31]
    s_waitcnt lgkmcnt(1)
    buffer_load_dwordx4 v6, s[20:23], s7 offen offset:3072 nt lds
    v_add_f32 v56, v56, v148
    v_add_f32 v57, v57, v149
    v_add_f32 v58, v58, v150
    v_add_f32 v59, v59, v151
    v_mfma_f32_16x16x32_bf16 v[32:35], a[244:247], v[240:243], v[32:35]
    v_add_f32 v60, v60, v156
    v_add_f32 v61, v61, v157
    v_add_f32 v62, v62, v158
    v_add_f32 v63, v63, v159
    v_mfma_f32_16x16x32_bf16 v[36:39], a[244:247], v[248:251], v[36:39]
    s_waitcnt lgkmcnt(0)
    v_or3_b32 v220, v220, v221, v222
    v_or_b32 v220, v220, v223
    s_nop 0
    v_readfirstlane_b32 s48, v220
    s_nop 1
    s_cmp_gt_u32 s48, s82
    s_cbranch_scc1 L_exact
    s_waitcnt vmcnt(16) lgkmcnt(0)
    s_barrier
    v_mfma_f32_16x16x32_bf16 v[40:43], a[248:251], v[232:235], v[40:43]
    ds_read_b64_tr_b16 a[192:193], v8 offset:32768
    ds_read_b64_tr_b16 a[194:195], v8 offset:34816
    v_mfma_f32_16x16x32_bf16 v[44:47], a[248:251], v[240:243], v[44:47]
    ds_read_b64_tr_b16 a[196:197], v9 offset:32768
    v_mfma_f32_16x16x32_bf16 v[48:51], a[248:251], v[248:251], v[48:51]
    ds_read_b64_tr_b16 a[198:199], v9 offset:34816
    v_mfma_f32_16x16x32_bf16 v[52:55], a[252:255], v[232:235], v[52:55]
    ds_read_b64_tr_b16 a[200:201], v10 offset:32768
    ds_read_b64_tr_b16 a[202:203], v10 offset:34816
    v_mfma_f32_16x16x32_bf16 v[56:59], a[252:255], v[240:243], v[56:59]
    ds_read_b64_tr_b16 a[204:205], v11 offset:32768
    v_mfma_f32_16x16x32_bf16 v[60:63], a[252:255], v[248:251], v[60:63]
    ds_read_b64_tr_b16 a[206:207], v11 offset:34816
    s_cmp_eq_u32 s36, 0
    s_cbranch_scc1 L_send_far
L_send_near:
    s_waitcnt lgkmcnt(6)
    v_mfma_f32_16x16x32_bf16 a[48:51], a[192:195], v[64:67], 0
    ds_read_b64_tr_b16 a[208:209], v8 offset:36864
    v_mfma_f32_16x16x32_bf16 a[52:55], a[192:195], v[72:75], 0
    ds_read_b64_tr_b16 a[210:211], v8 offset:38912
    v_mfma_f32_16x16x32_bf16 a[56:59], a[192:195], v[80:83], 0
    s_waitcnt lgkmcnt(6)
    ds_read_b64_tr_b16 a[212:213], v9 offset:36864
    v_cvt_pk_bf16_f32 v16, v16, v17
    v_cvt_pk_bf16_f32 v17, v18, v19
    v_cvt_pk_bf16_f32 v18, v20, v21
    v_mfma_f32_16x16x32_bf16 a[60:63], a[196:199], v[64:67], 0
    ds_read_b64_tr_b16 a[214:215], v9 offset:38912
    v_cvt_pk_bf16_f32 v19, v22, v23
    v_cvt_pk_bf16_f32 v24, v24, v25
    v_mfma_f32_16x16x32_bf16 a[64:67], a[196:199], v[72:75], 0
    s_add_u32 s37, s44, 0
    buffer_store_dwordx4 v[16:19], v5, s[24:27], s37 offen
    ds_read_b64_tr_b16 a[216:217], v10 offset:36864
    v_mfma_f32_16x16x32_bf16 a[68:71], a[196:199], v[80:83], 0
    s_waitcnt lgkmcnt(7)
    ds_read_b64_tr_b16 a[218:219], v10 offset:38912
    v_cvt_pk_bf16_f32 v25, v26, v27
    v_cvt_pk_bf16_f32 v26, v28, v29
    v_cvt_pk_bf16_f32 v27, v30, v31
    v_mfma_f32_16x16x32_bf16 a[72:75], a[200:203], v[64:67], 0
    s_add_u32 s37, s44, 4096
    buffer_store_dwordx4 v[24:27], v5, s[24:27], s37 offen
    ds_read_b64_tr_b16 a[220:221], v11 offset:36864
    v_mfma_f32_16x16x32_bf16 a[76:79], a[200:203], v[72:75], 0
    ds_read_b64_tr_b16 a[222:223], v11 offset:38912
    v_cvt_pk_bf16_f32 v32, v32, v33
    v_cvt_pk_bf16_f32 v33, v34, v35
    v_mfma_f32_16x16x32_bf16 a[80:83], a[200:203], v[80:83], 0
    s_waitcnt lgkmcnt(8)
    v_cvt_pk_bf16_f32 v34, v36, v37
    v_cvt_pk_bf16_f32 v35, v38, v39
    v_cvt_pk_bf16_f32 v40, v40, v41
    v_cvt_pk_bf16_f32 v41, v42, v43
    v_mfma_f32_16x16x32_bf16 a[84:87], a[204:207], v[64:67], 0
    s_add_u32 s37, s44, 8192
    buffer_store_dwordx4 v[32:35], v5, s[24:27], s37 offen
    v_cvt_pk_bf16_f32 v42, v44, v45
    v_mfma_f32_16x16x32_bf16 a[88:91], a[204:207], v[72:75], 0
    v_cvt_pk_bf16_f32 v43, v46, v47
    v_cvt_pk_bf16_f32 v48, v48, v49
    v_cvt_pk_bf16_f32 v49, v50, v51
    v_mfma_f32_16x16x32_bf16 a[92:95], a[204:207], v[80:83], 0
    s_add_u32 s37, s44, 12288
    buffer_store_dwordx4 v[40:43], v5, s[24:27], s37 offen
    v_cvt_pk_bf16_f32 v50, v52, v53
    s_waitcnt lgkmcnt(6)
    v_mfma_f32_16x16x32_bf16 a[48:51], a[208:211], v[88:91], a[48:51]
    v_cvt_pk_bf16_f32 v51, v54, v55
    v_cvt_pk_bf16_f32 v56, v56, v57
    v_cvt_pk_bf16_f32 v57, v58, v59
    v_cvt_pk_bf16_f32 v58, v60, v61
    v_mfma_f32_16x16x32_bf16 a[52:55], a[208:211], v[96:99], a[52:55]
    s_add_u32 s37, s44, 16384
    buffer_store_dwordx4 v[48:51], v5, s[24:27], s37 offen
    v_cvt_pk_bf16_f32 v59, v62, v63
    v_mfma_f32_16x16x32_bf16 a[56:59], a[208:211], v[104:107], a[56:59]
    s_waitcnt lgkmcnt(4)
    s_add_u32 s37, s44, 20480
    buffer_store_dwordx4 v[56:59], v5, s[24:27], s37 offen
    v_mov_b32 v20, v2
    v_mov_b32 v21, v12
    v_mfma_f32_16x16x32_bf16 a[60:63], a[212:215], v[88:91], a[60:63]
    v_mov_b32 v22, v3
    v_mov_b32 v23, v13
    v_mov_b32 v28, v4
    v_mfma_f32_16x16x32_bf16 a[64:67], a[212:215], v[96:99], a[64:67]
    v_mov_b32 v29, v14
    v_lshlrev_b32 v31, 4, v7
    v_lshlrev_b32 v30, 3, v7
    v_mfma_f32_16x16x32_bf16 a[68:71], a[212:215], v[104:107], a[68:71]
    s_mov_b64 exec, 0xffff
    buffer_store_dwordx4 v[20:23], v31, s[28:31], s40 offen offset:128
    buffer_store_dwordx2 v[28:29], v30, s[28:31], s40 offen offset:384
    s_mov_b64 exec, -1
L_send_join:
    s_add_u32 s8, s55, 16384
    s_add_u32 m0, s33, 24576
    s_nop 0
    buffer_load_dwordx4 v6, s[20:23], s8 offen offset:0 nt lds
    s_add_u32 s9, s55, 80896
    buffer_load_dwordx4 v6, s[20:23], s9 offen offset:1024 nt lds
    s_add_u32 s10, s55, 18432
    buffer_load_dwordx4 v6, s[20:23], s10 offen offset:2048 nt lds
    s_add_u32 s11, s55, 82944
    buffer_load_dwordx4 v6, s[20:23], s11 offen offset:3072 nt lds
    s_waitcnt vmcnt(24) lgkmcnt(0)
    s_barrier
    v_mfma_f32_16x16x32_bf16 a[72:75], a[216:219], v[88:91], a[72:75]
    s_add_u32 s4, s55, 32768
    s_add_u32 m0, s33, 32768
    ds_read_b64_tr_b16 a[224:225], v8 offset:40960
    ds_read_b64_tr_b16 a[226:227], v8 offset:43008
    v_mfma_f32_16x16x32_bf16 a[76:79], a[216:219], v[96:99], a[76:79]
    buffer_load_dwordx4 v6, s[20:23], s4 offen offset:0 nt lds
    v_mfma_f32_16x16x32_bf16 a[80:83], a[216:219], v[104:107], a[80:83]
    s_add_u32 s5, s55, 97280
    ds_read_b64_tr_b16 a[228:229], v9 offset:40960
    ds_read_b64_tr_b16 a[230:231], v9 offset:43008
    v_mfma_f32_16x16x32_bf16 a[84:87], a[220:223], v[88:91], a[84:87]
    buffer_load_dwordx4 v6, s[20:23], s5 offen offset:1024 nt lds
    v_mfma_f32_16x16x32_bf16 a[88:91], a[220:223], v[96:99], a[88:91]
    s_add_u32 s6, s55, 34816
    ds_read_b64_tr_b16 a[232:233], v10 offset:40960
    ds_read_b64_tr_b16 a[234:235], v10 offset:43008
    v_mfma_f32_16x16x32_bf16 a[92:95], a[220:223], v[104:107], a[92:95]
    s_waitcnt lgkmcnt(4)
    buffer_load_dwordx4 v6, s[20:23], s6 offen offset:2048 nt lds
    v_mfma_f32_16x16x32_bf16 a[48:51], a[224:227], v[112:115], a[48:51]
    s_add_u32 s7, s55, 99328
    ds_read_b64_tr_b16 a[236:237], v11 offset:40960
    ds_read_b64_tr_b16 a[238:239], v11 offset:43008
    v_mfma_f32_16x16x32_bf16 a[52:55], a[224:227], v[120:123], a[52:55]
    s_waitcnt vmcnt(7)
    v_mov_b32 v159, s43
    s_mov_b64 exec, 1
    s_cmp_eq_u32 s36, 0
    s_cbranch_scc1 L_flag_far
L_flag_near:
    buffer_store_dword v159, off, s[28:31], s40
L_flag_join:
    s_mov_b64 exec, -1
    buffer_load_dwordx4 v6, s[20:23], s7 offen offset:3072 nt lds
    v_mfma_f32_16x16x32_bf16 a[56:59], a[224:227], v[128:131], a[56:59]
    s_waitcnt lgkmcnt(4)
    ds_read_b64_tr_b16 a[240:241], v8 offset:45056
    v_mfma_f32_16x16x32_bf16 a[60:63], a[228:231], v[112:115], a[60:63]
    ds_read_b64_tr_b16 a[242:243], v8 offset:47104
    v_mfma_f32_16x16x32_bf16 a[64:67], a[228:231], v[120:123], a[64:67]
    ds_read_b64_tr_b16 a[244:245], v9 offset:45056
    v_mfma_f32_16x16x32_bf16 a[68:71], a[228:231], v[128:131], a[68:71]
    s_waitcnt lgkmcnt(5)
    ds_read_b64_tr_b16 a[246:247], v9 offset:47104
    v_mfma_f32_16x16x32_bf16 a[72:75], a[232:235], v[112:115], a[72:75]
    ds_read_b64_tr_b16 a[248:249], v10 offset:45056
    v_mfma_f32_16x16x32_bf16 a[76:79], a[232:235], v[120:123], a[76:79]
    ds_read_b64_tr_b16 a[250:251], v10 offset:47104
    v_mfma_f32_16x16x32_bf16 a[80:83], a[232:235], v[128:131], a[80:83]
    s_waitcnt lgkmcnt(6)
    ds_read_b64_tr_b16 a[252:253], v11 offset:45056
    v_mfma_f32_16x16x32_bf16 a[84:87], a[236:239], v[112:115], a[84:87]
    ds_read_b64_tr_b16 a[254:255], v11 offset:47104
    v_mfma_f32_16x16x32_bf16 a[88:91], a[236:239], v[120:123], a[88:91]
    v_mfma_f32_16x16x32_bf16 a[92:95], a[236:239], v[128:131], a[92:95]
    s_waitcnt lgkmcnt(6)
    v_mfma_f32_16x16x32_bf16 a[48:51], a[240:243], v[136:139], a[48:51]
    v_mfma_f32_16x16x32_bf16 a[52:55], a[240:243], v[144:147], a[52:55]
    v_mfma_f32_16x16x32_bf16 a[56:59], a[240:243], v[152:155], a[56:59]
    s_waitcnt lgkmcnt(4)
    v_mfma_f32_16x16x32_bf16 a[60:63], a[244:247], v[136:139], a[60:63]
    v_mfma_f32_16x16x32_bf16 a[64:67], a[244:247], v[144:147], a[64:67]
    v_mfma_f32_16x16x32_bf16 a[68:71], a[244:247], v[152:155], a[68:71]
    s_waitcnt vmcnt(25) lgkmcnt(0)
    s_barrier
    v_mfma_f32_16x16x32_bf16 a[72:75], a[248:251], v[136:139], a[72:75]
    s_add_u32 s8, s55, 49152
    s_add_u32 m0, s33, 40960
    ds_read_b64_tr_b16 a[192:193], v8 offset:0
    ds_read_b64_tr_b16 a[194:195], v8 offset:2048
    v_mfma_f32_16x16x32_bf16 a[76:79], a[248:251], v[144:147], a[76:79]
    buffer_load_dwordx4 v6, s[20:23], s8 offen offset:0 nt lds
    v_mfma_f32_16x16x32_bf16 a[80:83], a[248:251], v[152:155], a[80:83]
    s_add_u32 s9, s55, 113664
    ds_read_b64_tr_b16 a[196:197], v9 offset:0
    ds_read_b64_tr_b16 a[198:199], v9 offset:2048
    v_mfma_f32_16x16x32_bf16 a[84:87], a[252:255], v[136:139], a[84:87]
    buffer_load_dwordx4 v6, s[20:23], s9 offen offset:1024 nt lds
    v_mfma_f32_16x16x32_bf16 a[88:91], a[252:255], v[144:147], a[88:91]
    s_add_u32 s10, s55, 51200
    ds_read_b64_tr_b16 a[200:201], v10 offset:0
    ds_read_b64_tr_b16 a[202:203], v10 offset:2048
    v_mfma_f32_16x16x32_bf16 a[92:95], a[252:255], v[152:155], a[92:95]
    s_waitcnt lgkmcnt(4)
    buffer_load_dwordx4 v6, s[20:23], s10 offen offset:2048 nt lds
    v_mfma_f32_16x16x32_bf16 a[48:51], a[192:195], v[160:163], a[48:51]
    s_add_u32 s11, s55, 115712
    ds_read_b64_tr_b16 a[204:205], v11 offset:0
    ds_read_b64_tr_b16 a[206:207], v11 offset:2048
    v_mfma_f32_16x16x32_bf16 a[52:55], a[192:195], v[168:171], a[52:55]
    buffer_load_dwordx4 v6, s[20:23], s11 offen offset:3072 nt lds
    v_mfma_f32_16x16x32_bf16 a[56:59], a[192:195], v[176:179], a[56:59]
    s_waitcnt lgkmcnt(4)
    ds_read_b64_tr_b16 a[208:209], v8 offset:4096
    v_mbcnt_lo_u32_b32 v127, -1, 0
    v_mfma_f32_16x16x32_bf16 a[60:63], a[196:199], v[160:163], a[60:63]
    ds_read_b64_tr_b16 a[210:211], v8 offset:6144
    v_mbcnt_hi_u32_b32 v127, -1, v127
    v_and_b32 v132, 15, v127
    v_mfma_f32_16x16x32_bf16 a[64:67], a[196:199], v[168:171], a[64:67]
    ds_read_b64_tr_b16 a[212:213], v9 offset:4096
    v_lshlrev_b32 v133, 4, v132
    v_mfma_f32_16x16x32_bf16 a[68:71], a[196:199], v[176:179], a[68:71]
    s_waitcnt lgkmcnt(5)
    ds_read_b64_tr_b16 a[214:215], v9 offset:6144
    v_lshlrev_b32 v134, 3, v132
    v_lshrrev_b32 v135, 3, v127
    v_mfma_f32_16x16x32_bf16 a[72:75], a[200:203], v[160:163], a[72:75]
    ds_read_b64_tr_b16 a[216:217], v10 offset:4096
    v_lshlrev_b32 v135, 5, v135
    v_mfma_f32_16x16x32_bf16 a[76:79], a[200:203], v[168:171], a[76:79]
    ds_read_b64_tr_b16 a[218:219], v10 offset:6144
    v_and_or_b32 v135, v127, 7, v135
    v_mfma_f32_16x16x32_bf16 a[80:83], a[200:203], v[176:179], a[80:83]
    s_waitcnt lgkmcnt(6)
    ds_read_b64_tr_b16 a[220:221], v11 offset:4096
    v_lshlrev_b32 v135, 4, v135
    s_mul_i32 s48, s32, 12288
    s_add_u32 s48, s48, 98304
    v_lshrrev_b32 v156, 5, v127
    v_mfma_f32_16x16x32_bf16 a[84:87], a[204:207], v[160:163], a[84:87]
    ds_read_b64_tr_b16 a[222:223], v11 offset:6144
    v_and_b32 v157, 7, v132
    v_mfma_f32_16x16x32_bf16 a[88:91], a[204:207], v[168:171], a[88:91]
    v_xor_b32 v156, v156, v157
    v_lshlrev_b32 v156, 4, v156
    v_mfma_f32_16x16x32_bf16 a[92:95], a[204:207], v[176:179], a[92:95]
    s_waitcnt lgkmcnt(6)
    v_bfe_u32 v157, v127, 4, 1
    v_lshl_add_u32 v156, v157, 3, v156
    v_lshl_add_u32 v156, v132, 7, v156
    v_mfma_f32_16x16x32_bf16 a[48:51], a[208:211], v[184:187], a[48:51]
    v_xor_b32 v140, 0, v156
    v_add_u32 v140, s48, v140
    v_mfma_f32_16x16x32_bf16 a[52:55], a[208:211], v[192:195], a[52:55]
    v_xor_b32 v141, 32, v156
    v_add_u32 v141, s48, v141
    v_xor_b32 v142, 64, v156
    v_mfma_f32_16x16x32_bf16 a[56:59], a[208:211], v[200:203], a[56:59]
    s_waitcnt lgkmcnt(4)
    v_add_u32 v142, s48, v142
    v_xor_b32 v143, 96, v156
    v_mfma_f32_16x16x32_bf16 a[60:63], a[212:215], v[184:187], a[60:63]
    v_add_u32 v143, s48, v143
    v_lshrrev_b32 v156, 3, v127
    v_mfma_f32_16x16x32_bf16 a[64:67], a[212:215], v[192:195], a[64:67]
    v_xor_b32 v157, v156, v127
    v_and_b32 v157, 7, v157
    v_lshlrev_b32 v157, 4, v157
    v_mfma_f32_16x16x32_bf16 a[68:71], a[212:215], v[200:203], a[68:71]
    v_lshl_add_u32 v156, v156, 7, v157
    v_add_u32 v148, s48, v156
    s_waitcnt vmcnt(25) lgkmcnt(0)
    s_barrier
    v_mfma_f32_16x16x32_bf16 a[72:75], a[216:219], v[184:187], a[72:75]
    ds_read_b64_tr_b16 a[224:225], v8 offset:8192
    ds_read_b64_tr_b16 a[226:227], v8 offset:10240
    v_mfma_f32_16x16x32_bf16 a[76:79], a[216:219], v[192:195], a[76:79]
    s_cmp_eq_u32 s36, 0
    s_cbranch_scc1 L_pollq_far
L_pollq_near:
    buffer_load_dword v126, off, s[28:31], s41 nt
L_pollq_join:
    v_mfma_f32_16x16x32_bf16 a[80:83], a[216:219], v[200:203], a[80:83]
    ds_read_b64_tr_b16 a[228:229], v9 offset:8192
    ds_read_b64_tr_b16 a[230:231], v9 offset:10240
    v_mfma_f32_16x16x32_bf16 a[84:87], a[220:223], v[184:187], a[84:87]
    v_mfma_f32_16x16x32_bf16 a[88:91], a[220:223], v[192:195], a[88:91]
    ds_read_b64_tr_b16 a[232:233], v10 offset:8192
    ds_read_b64_tr_b16 a[234:235], v10 offset:10240
    v_mfma_f32_16x16x32_bf16 a[92:95], a[220:223], v[200:203], a[92:95]
    s_waitcnt lgkmcnt(4)
    v_mfma_f32_16x16x32_bf16 a[48:51], a[224:227], v[208:211], a[48:51]
    ds_read_b64_tr_b16 a[236:237], v11 offset:8192
    ds_read_b64_tr_b16 a[238:239], v11 offset:10240
    v_mfma_f32_16x16x32_bf16 a[52:55], a[224:227], v[216:219], a[52:55]
    v_mfma_f32_16x16x32_bf16 a[56:59], a[224:227], v[224:227], a[56:59]
    s_waitcnt lgkmcnt(4)
    ds_read_b64_tr_b16 a[240:241], v8 offset:12288
    v_mfma_f32_16x16x32_bf16 a[60:63], a[228:231], v[208:211], a[60:63]
    ds_read_b64_tr_b16 a[242:243], v8 offset:14336
    v_mfma_f32_16x16x32_bf16 a[64:67], a[228:231], v[216:219], a[64:67]
    ds_read_b64_tr_b16 a[244:245], v9 offset:12288
    v_mfma_f32_16x16x32_bf16 a[68:71], a[228:231], v[224:227], a[68:71]
    s_waitcnt lgkmcnt(5)
    ds_read_b64_tr_b16 a[246:247], v9 offset:14336
    v_mfma_f32_16x16x32_bf16 a[72:75], a[232:235], v[208:211], a[72:75]
    ds_read_b64_tr_b16 a[248:249], v10 offset:12288
    v_mfma_f32_16x16x32_bf16 a[76:79], a[232:235], v[216:219], a[76:79]
    ds_read_b64_tr_b16 a[250:251], v10 offset:14336
    v_mfma_f32_16x16x32_bf16 a[80:83], a[232:235], v[224:227], a[80:83]
    s_waitcnt lgkmcnt(6)
    ds_read_b64_tr_b16 a[252:253], v11 offset:12288
    v_mfma_f32_16x16x32_bf16 a[84:87], a[236:239], v[208:211], a[84:87]
    ds_read_b64_tr_b16 a[254:255], v11 offset:14336
    v_mfma_f32_16x16x32_bf16 a[88:91], a[236:239], v[216:219], a[88:91]
    v_mfma_f32_16x16x32_bf16 a[92:95], a[236:239], v[224:227], a[92:95]
    s_waitcnt lgkmcnt(6)
    v_mfma_f32_16x16x32_bf16 a[48:51], a[240:243], v[232:235], a[48:51]
    v_mfma_f32_16x16x32_bf16 a[52:55], a[240:243], v[240:243], a[52:55]
    v_mfma_f32_16x16x32_bf16 a[56:59], a[240:243], v[248:251], a[56:59]
    s_waitcnt lgkmcnt(4)
    v_mfma_f32_16x16x32_bf16 a[60:63], a[244:247], v[232:235], a[60:63]
    v_mfma_f32_16x16x32_bf16 a[64:67], a[244:247], v[240:243], a[64:67]
    v_mfma_f32_16x16x32_bf16 a[68:71], a[244:247], v[248:251], a[68:71]
    s_waitcnt vmcnt(22) lgkmcnt(0)
    s_barrier
    v_mfma_f32_16x16x32_bf16 a[72:75], a[248:251], v[232:235], a[72:75]
    ds_read_b64_tr_b16 a[192:193], v8 offset:16384
    ds_read_b64_tr_b16 a[194:195], v8 offset:18432
    v_mfma_f32_16x16x32_bf16 a[76:79], a[248:251], v[240:243], a[76:79]
    ds_read_b64_tr_b16 a[196:197], v9 offset:16384
    ds_read_b64_tr_b16 a[198:199], v9 offset:18432
    v_mfma_f32_16x16x32_bf16 a[80:83], a[248:251], v[248:251], a[80:83]
    ds_read_b64_tr_b16 a[200:201], v10 offset:16384
    ds_read_b64_tr_b16 a[202:203], v10 offset:18432
    v_mfma_f32_16x16x32_bf16 a[84:87], a[252:255], v[232:235], a[84:87]
    ds_read_b64_tr_b16 a[204:205], v11 offset:16384
    ds_read_b64_tr_b16 a[206:207], v11 offset:18432
    v_mfma_f32_16x16x32_bf16 a[88:91], a[252:255], v[240:243], a[88:91]
    ds_read_b64_tr_b16 a[208:209], v8 offset:20480
    ds_read_b64_tr_b16 a[210:211], v8 offset:22528
    v_mfma_f32_16x16x32_bf16 a[92:95], a[252:255], v[248:251], a[92:95]
    s_waitcnt lgkmcnt(8)
    ds_read_b64_tr_b16 a[212:213], v9 offset:20480
    ds_read_b64_tr_b16 a[214:215], v9 offset:22528
    v_mfma_f32_16x16x32_bf16 v[16:19], a[192:195], v[64:67], 0
    ds_read_b64_tr_b16 a[216:217], v10 offset:20480
    ds_read_b64_tr_b16 a[218:219], v10 offset:22528
    v_mfma_f32_16x16x32_bf16 v[20:23], a[192:195], v[72:75], 0
    ds_read_b64_tr_b16 a[220:221], v11 offset:20480
    ds_read_b64_tr_b16 a[222:223], v11 offset:22528
    v_mfma_f32_16x16x32_bf16 v[24:27], a[192:195], v[80:83], 0
    s_waitcnt lgkmcnt(12)
    v_mfma_f32_16x16x32_bf16 v[28:31], a[196:199], v[64:67], 0
    v_mfma_f32_16x16x32_bf16 v[32:35], a[196:199], v[72:75], 0
    v_mfma_f32_16x16x32_bf16 v[36:39], a[196:199], v[80:83], 0
    s_waitcnt lgkmcnt(10)
    ds_write_b128 v0, a[48:51] offset:0
    v_mfma_f32_16x16x32_bf16 v[40:43], a[200:203], v[64:67], 0
    v_mfma_f32_16x16x32_bf16 v[44:47], a[200:203], v[72:75], 0
    v_mfma_f32_16x16x32_bf16 v[48:51], a[200:203], v[80:83], 0
    s_waitcnt lgkmcnt(9)
    ds_write_b128 v0, a[52:55] offset:1024
    v_mfma_f32_16x16x32_bf16 v[52:55], a[204:207], v[64:67], 0
    v_mfma_f32_16x16x32_bf16 v[56:59], a[204:207], v[72:75], 0
    v_mfma_f32_16x16x32_bf16 v[60:63], a[204:207], v[80:83], 0
    s_waitcnt lgkmcnt(8)
    ds_write_b128 v0, a[56:59] offset:2048
    v_mfma_f32_16x16x32_bf16 v[16:19], a[208:211], v[88:91], v[16:19]
    v_mfma_f32_16x16x32_bf16 v[20:23], a[208:211], v[96:99], v[20:23]
    v_mfma_f32_16x16x32_bf16 v[24:27], a[208:211], v[104:107], v[24:27]
    s_waitcnt lgkmcnt(7)
    ds_write_b128 v0, a[60:63] offset:3072
    v_mfma_f32_16x16x32_bf16 v[28:31], a[212:215], v[88:91], v[28:31]
    v_mfma_f32_16x16x32_bf16 v[32:35], a[212:215], v[96:99], v[32:35]
    v_mfma_f32_16x16x32_bf16 v[36:39], a[212:215], v[104:107], v[36:39]
    s_waitcnt vmcnt(0)
    v_readfirstlane_b32 s47, v126
    s_nop 1
    s_cmp_lg_u32 s47, s42
    s_cbranch_scc1 L_poll_spin
L_poll_ok:
    s_waitcnt vmcnt(10) lgkmcnt(0)
    s_barrier
    s_cmp_eq_u32 s36, 0
    s_cbranch_scc1 L_recv_far
L_recv_near:
    v_mfma_f32_16x16x32_bf16 v[40:43], a[216:219], v[88:91], v[40:43]
    ds_read_b64_tr_b16 a[224:225], v8 offset:24576
    ds_read_b64_tr_b16 a[226:227], v8 offset:26624
    v_mfma_f32_16x16x32_bf16 v[44:47], a[216:219], v[96:99], v[44:47]
    ds_read_b64_tr_b16 a[228:229], v9 offset:24576
    ds_read_b64_tr_b16 a[230:231], v9 offset:26624
    v_mfma_f32_16x16x32_bf16 v[48:51], a[216:219], v[104:107], v[48:51]
    ds_read_b64_tr_b16 a[232:233], v10 offset:24576
    ds_read_b64_tr_b16 a[234:235], v10 offset:26624
    v_mfma_f32_16x16x32_bf16 v[52:55], a[220:223], v[88:91], v[52:55]
    ds_read_b64_tr_b16 a[236:237], v11 offset:24576
    ds_read_b64_tr_b16 a[238:239], v11 offset:26624
    v_mfma_f32_16x16x32_bf16 v[56:59], a[220:223], v[96:99], v[56:59]
    ds_read_b64_tr_b16 a[240:241], v8 offset:28672
    ds_read_b64_tr_b16 a[242:243], v8 offset:30720
    v_mfma_f32_16x16x32_bf16 v[60:63], a[220:223], v[104:107], v[60:63]
    s_waitcnt lgkmcnt(8)
    ds_read_b64_tr_b16 a[244:245], v9 offset:28672
    ds_read_b64_tr_b16 a[246:247], v9 offset:30720
    v_mfma_f32_16x16x32_bf16 v[16:19], a[224:227], v[112:115], v[16:19]
    ds_read_b64_tr_b16 a[248:249], v10 offset:28672
    ds_read_b64_tr_b16 a[250:251], v10 offset:30720
    v_mfma_f32_16x16x32_bf16 v[20:23], a[224:227], v[120:123], v[20:23]
    ds_read_b64_tr_b16 a[252:253], v11 offset:28672
    ds_read_b64_tr_b16 a[254:255], v11 offset:30720
    v_mfma_f32_16x16x32_bf16 v[24:27], a[224:227], v[128:131], v[24:27]
    s_waitcnt lgkmcnt(12)
    ds_read_b128 v[164:167], v1 offset:0
    ds_read_b128 v[172:175], v1 offset:1024
    buffer_load_dwordx4 v[116:119], v133, s[28:31], s41 offen offset:128 nt
    v_mfma_f32_16x16x32_bf16 v[28:31], a[228:231], v[112:115], v[28:31]
    ds_read_b128 v[180:183], v1 offset:2048
    s_waitcnt lgkmcnt(11)
    ds_read_b128 v[188:191], v1 offset:3072
    buffer_load_dwordx2 v[124:125], v134, s[28:31], s41 offen offset:384 nt
    s_add_u32 s88, s45, 0
    v_mfma_f32_16x16x32_bf16 v[32:35], a[228:231], v[120:123], v[32:35]
    buffer_load_dwordx4 v[68:71], v5, s[24:27], s88 offen nt
    v_mfma_f32_16x16x32_bf16 v[36:39], a[228:231], v[128:131], v[36:39]
    s_add_u32 s89, s45, 4096
    ds_write_b128 v0, a[64:67] offset:4096
    v_mfma_f32_16x16x32_bf16 v[40:43], a[232:235], v[112:115], v[40:43]
    buffer_load_dwordx4 v[76:79], v5, s[24:27], s89 offen nt
    s_add_u32 s90, s45, 8192
    v_mfma_f32_16x16x32_bf16 v[44:47], a[232:235], v[120:123], v[44:47]
    buffer_load_dwordx4 v[84:87], v5, s[24:27], s90 offen nt
    v_mfma_f32_16x16x32_bf16 v[48:51], a[232:235], v[128:131], v[48:51]
    s_add_u32 s91, s45, 12288
    ds_write_b128 v0, a[68:71] offset:5120
    v_mfma_f32_16x16x32_bf16 v[52:55], a[236:239], v[112:115], v[52:55]
    buffer_load_dwordx4 v[92:95], v5, s[24:27], s91 offen nt
    s_add_u32 s88, s45, 16384
    v_mfma_f32_16x16x32_bf16 v[56:59], a[236:239], v[120:123], v[56:59]
    buffer_load_dwordx4 v[100:103], v5, s[24:27], s88 offen nt
    v_mfma_f32_16x16x32_bf16 v[60:63], a[236:239], v[128:131], v[60:63]
    s_waitcnt lgkmcnt(12)
    s_add_u32 s89, s45, 20480
    ds_write_b128 v0, a[72:75] offset:6144
    v_mfma_f32_16x16x32_bf16 v[16:19], a[240:243], v[136:139], v[16:19]
    buffer_load_dwordx4 v[108:111], v5, s[24:27], s89 offen nt
    v_mfma_f32_16x16x32_bf16 v[20:23], a[240:243], v[144:147], v[20:23]
    v_mfma_f32_16x16x32_bf16 v[24:27], a[240:243], v[152:155], v[24:27]
    s_waitcnt lgkmcnt(11)
    ds_write_b128 v0, a[76:79] offset:7168
    v_mfma_f32_16x16x32_bf16 v[28:31], a[244:247], v[136:139], v[28:31]
    v_mfma_f32_16x16x32_bf16 v[32:35], a[244:247], v[144:147], v[32:35]
    v_mfma_f32_16x16x32_bf16 v[36:39], a[244:247], v[152:155], v[36:39]
L_recv_join:
    s_waitcnt vmcnt(13) lgkmcnt(0)
    s_barrier
    v_mfma_f32_16x16x32_bf16 v[40:43], a[248:251], v[136:139], v[40:43]
    ds_read_b64_tr_b16 a[192:193], v8 offset:32768
    ds_read_b64_tr_b16 a[194:195], v8 offset:34816
    v_mfma_f32_16x16x32_bf16 v[44:47], a[248:251], v[144:147], v[44:47]
    ds_read_b64_tr_b16 a[196:197], v9 offset:32768
    ds_read_b64_tr_b16 a[198:199], v9 offset:34816
    v_mfma_f32_16x16x32_bf16 v[48:51], a[248:251], v[152:155], v[48:51]
    ds_read_b64_tr_b16 a[200:201], v10 offset:32768
    ds_read_b64_tr_b16 a[202:203], v10 offset:34816
    v_mfma_f32_16x16x32_bf16 v[52:55], a[252:255], v[136:139], v[52:55]
    ds_read_b64_tr_b16 a[204:205], v11 offset:32768
    ds_read_b64_tr_b16 a[206:207], v11 offset:34816
    v_mfma_f32_16x16x32_bf16 v[56:59], a[252:255], v[144:147], v[56:59]
    ds_read_b64_tr_b16 a[208:209], v8 offset:36864
    ds_read_b64_tr_b16 a[210:211], v8 offset:38912
    v_mfma_f32_16x16x32_bf16 v[60:63], a[252:255], v[152:155], v[60:63]
    s_waitcnt lgkmcnt(8)
    ds_read_b64_tr_b16 a[212:213], v9 offset:36864
    ds_read_b64_tr_b16 a[214:215], v9 offset:38912
    v_mfma_f32_16x16x32_bf16 v[16:19], a[192:195], v[160:163], v[16:19]
    ds_read_b64_tr_b16 a[216:217], v10 offset:36864
    ds_read_b64_tr_b16 a[218:219], v10 offset:38912
    v_mfma_f32_16x16x32_bf16 v[20:23], a[192:195], v[168:171], v[20:23]
    ds_read_b64_tr_b16 a[220:221], v11 offset:36864
    ds_read_b64_tr_b16 a[222:223], v11 offset:38912
    v_mfma_f32_16x16x32_bf16 v[24:27], a[192:195], v[176:179], v[24:27]
    s_waitcnt lgkmcnt(12)
    ds_read_b128 v[196:199], v1 offset:4096
    ds_read_b128 v[204:207], v1 offset:5120
    v_mfma_f32_16x16x32_bf16 v[28:31], a[196:199], v[160:163], v[28:31]
    ds_read_b128 v[212:215], v1 offset:6144
    s_waitcnt lgkmcnt(11)
    ds_read_b128 v[220:223], v1 offset:7168
    v_mfma_f32_16x16x32_bf16 v[32:35], a[196:199], v[168:171], v[32:35]
    v_mfma_f32_16x16x32_bf16 v[36:39], a[196:199], v[176:179], v[36:39]
    ds_write_b128 v0, a[80:83] offset:8192
    v_add_f32 v16, v16, v164
    v_add_f32 v17, v17, v165
    v_add_f32 v18, v18, v166
    v_add_f32 v19, v19, v167
    v_mfma_f32_16x16x32_bf16 v[40:43], a[200:203], v[160:163], v[40:43]
    v_add_f32 v20, v20, v172
    v_add_f32 v21, v21, v173
    v_add_f32 v22, v22, v174
    v_add_f32 v23, v23, v175
    v_mfma_f32_16x16x32_bf16 v[44:47], a[200:203], v[168:171], v[44:47]
    v_add_f32 v24, v24, v180
    v_add_f32 v25, v25, v181
    v_add_f32 v26, v26, v182
    v_add_f32 v27, v27, v183
    v_mfma_f32_16x16x32_bf16 v[48:51], a[200:203], v[176:179], v[48:51]
    ds_write_b128 v0, a[84:87] offset:9216
    v_add_f32 v28, v28, v188
    v_add_f32 v29, v29, v189
    v_add_f32 v30, v30, v190
    v_add_f32 v31, v31, v191
    v_mfma_f32_16x16x32_bf16 v[52:55], a[204:207], v[160:163], v[52:55]
    s_waitcnt lgkmcnt(4)
    v_add_f32 v32, v32, v196
    v_add_f32 v33, v33, v197
    v_add_f32 v34, v34, v198
    v_add_f32 v35, v35, v199
    v_mfma_f32_16x16x32_bf16 v[56:59], a[204:207], v[168:171], v[56:59]
    v_add_f32 v36, v36, v204
    v_add_f32 v37, v37, v205
    v_add_f32 v38, v38, v206
    v_add_f32 v39, v39, v207
    v_mfma_f32_16x16x32_bf16 v[60:63], a[204:207], v[176:179], v[60:63]
    s_waitcnt lgkmcnt(2)
    ds_write_b128 v0, a[88:91] offset:10240
    v_add_f32 v40, v40, v212
    v_add_f32 v41, v41, v213
    v_add_f32 v42, v42, v214
    v_add_f32 v43, v43, v215
    v_mfma_f32_16x16x32_bf16 v[16:19], a[208:211], v[184:187], v[16:19]
    v_add_f32 v44, v44, v220
    v_add_f32 v45, v45, v221
    v_add_f32 v46, v46, v222
    v_add_f32 v47, v47, v223
    v_mfma_f32_16x16x32_bf16 v[20:23], a[208:211], v[192:195], v[20:23]
    v_mfma_f32_16x16x32_bf16 v[24:27], a[208:211], v[200:203], v[24:27]
    ds_write_b128 v0, a[92:95] offset:11264
    v_mfma_f32_16x16x32_bf16 v[28:31], a[212:215], v[184:187], v[28:31]
    v_mfma_f32_16x16x32_bf16 v[32:35], a[212:215], v[192:195], v[32:35]
    v_mfma_f32_16x16x32_bf16 v[36:39], a[212:215], v[200:203], v[36:39]
    s_waitcnt vmcnt(9) lgkmcnt(0)
    s_barrier
    s_mov_b32 s47, 0xffff0000
    v_mfma_f32_16x16x32_bf16 v[40:43], a[216:219], v[184:187], v[40:43]
    ds_read_b64_tr_b16 a[224:225], v8 offset:40960
    ds_read_b64_tr_b16 a[226:227], v8 offset:43008
    v_mfma_f32_16x16x32_bf16 v[44:47], a[216:219], v[192:195], v[44:47]
    ds_read_b64_tr_b16 a[228:229], v9 offset:40960
    ds_read_b64_tr_b16 a[230:231], v9 offset:43008
    v_mfma_f32_16x16x32_bf16 v[48:51], a[216:219], v[200:203], v[48:51]
    ds_read_b64_tr_b16 a[232:233], v10 offset:40960
    ds_read_b64_tr_b16 a[234:235], v10 offset:43008
    v_mfma_f32_16x16x32_bf16 v[52:55], a[220:223], v[184:187], v[52:55]
    ds_read_b64_tr_b16 a[236:237], v11 offset:40960
    ds_read_b64_tr_b16 a[238:239], v11 offset:43008
    v_mfma_f32_16x16x32_bf16 v[56:59], a[220:223], v[192:195], v[56:59]
    ds_read_b64_tr_b16 a[240:241], v8 offset:45056
    v_mfma_f32_16x16x32_bf16 v[60:63], a[220:223], v[200:203], v[60:63]
    s_waitcnt lgkmcnt(7)
    ds_read_b64_tr_b16 a[242:243], v8 offset:47104
    v_mfma_f32_16x16x32_bf16 v[16:19], a[224:227], v[208:211], v[16:19]
    ds_read_b64_tr_b16 a[244:245], v9 offset:45056
    v_mfma_f32_16x16x32_bf16 v[20:23], a[224:227], v[216:219], v[20:23]
    ds_read_b64_tr_b16 a[246:247], v9 offset:47104
    v_mfma_f32_16x16x32_bf16 v[24:27], a[224:227], v[224:227], v[24:27]
    s_waitcnt lgkmcnt(8)
    ds_read_b64_tr_b16 a[248:249], v10 offset:45056
    s_waitcnt vmcnt(6)
    v_max_f32 v149, v2, v116
    v_mfma_f32_16x16x32_bf16 v[28:31], a[228:231], v[208:211], v[28:31]
    ds_read_b64_tr_b16 a[250:251], v10 offset:47104
    v_max_f32 v150, v3, v118
    v_mfma_f32_16x16x32_bf16 v[32:35], a[228:231], v[216:219], v[32:35]
    ds_read_b64_tr_b16 a[252:253], v11 offset:45056
    v_max_f32 v151, v4, v124
    v_mfma_f32_16x16x32_bf16 v[36:39], a[228:231], v[224:227], v[36:39]
    s_waitcnt lgkmcnt(9)
    ds_read_b64_tr_b16 a[254:255], v11 offset:47104
    v_sub_f32 v156, v2, v149
    v_mfma_f32_16x16x32_bf16 v[40:43], a[232:235], v[208:211], v[40:43]
    ds_read_b128 v[228:231], v1 offset:8192
    v_sub_f32 v157, v3, v150
    v_mfma_f32_16x16x32_bf16 v[44:47], a[232:235], v[216:219], v[44:47]
    ds_read_b128 v[236:239], v1 offset:9216
    v_sub_f32 v158, v4, v151
    v_mfma_f32_16x16x32_bf16 v[48:51], a[232:235], v[224:227], v[48:51]
    s_waitcnt lgkmcnt(10)
    ds_read_b128 v[244:247], v1 offset:10240
    v_sub_f32 v64, v116, v149
    v_mfma_f32_16x16x32_bf16 v[52:55], a[236:239], v[208:211], v[52:55]
    ds_read_b128 v[252:255], v1 offset:11264
    v_sub_f32 v65, v118, v150
    v_mfma_f32_16x16x32_bf16 v[56:59], a[236:239], v[216:219], v[56:59]
    v_exp_f32 v156, v156
    v_mfma_f32_16x16x32_bf16 v[60:63], a[236:239], v[224:227], v[60:63]
    s_waitcnt lgkmcnt(10)
    v_exp_f32 v157, v157
    v_mfma_f32_16x16x32_bf16 v[16:19], a[240:243], v[232:235], v[16:19]
    v_exp_f32 v158, v158
    v_mfma_f32_16x16x32_bf16 v[20:23], a[240:243], v[240:243], v[20:23]
    v_exp_f32 v64, v64
    v_mfma_f32_16x16x32_bf16 v[24:27], a[240:243], v[248:251], v[24:27]
    s_waitcnt lgkmcnt(8)
    v_exp_f32 v65, v65
    v_mfma_f32_16x16x32_bf16 v[28:31], a[244:247], v[232:235], v[28:31]
    v_sub_f32 v66, v124, v151
    v_mul_f32 v149, v156, v12
    v_mfma_f32_16x16x32_bf16 v[32:35], a[244:247], v[240:243], v[32:35]
    v_exp_f32 v66, v66
    v_mfma_f32_16x16x32_bf16 v[36:39], a[244:247], v[248:251], v[36:39]
    s_waitcnt lgkmcnt(6)
    v_mul_f32 v150, v157, v13
    v_mul_f32 v151, v158, v14
    v_mfma_f32_16x16x32_bf16 v[40:43], a[248:251], v[232:235], v[40:43]
    v_fma_f32 v149, v64, v117, v149
    v_fma_f32 v150, v65, v119, v150
    v_mfma_f32_16x16x32_bf16 v[44:47], a[248:251], v[240:243], v[44:47]
    v_rcp_f32 v149, v149
    v_mfma_f32_16x16x32_bf16 v[48:51], a[248:251], v[248:251], v[48:51]
    s_waitcnt lgkmcnt(4)
    v_rcp_f32 v150, v150
    v_mfma_f32_16x16x32_bf16 v[52:55], a[252:255], v[232:235], v[52:55]
    v_fma_f32 v151, v66, v125, v151
    v_mul_f32 v156, v156, v149
    v_mfma_f32_16x16x32_bf16 v[56:59], a[252:255], v[240:243], v[56:59]
    v_rcp_f32 v151, v151
    v_mfma_f32_16x16x32_bf16 v[60:63], a[252:255], v[248:251], v[60:63]
    v_mul_f32 v157, v157, v150
    v_mul_f32 v158, v158, v151
    v_mul_f32 v64, v64, v149
    v_mul_f32 v65, v65, v150
    v_mul_f32 v66, v66, v151
    s_waitcnt vmcnt(5)
    v_lshlrev_b32 v72, 16, v68
    v_and_b32 v73, s47, v68
    v_lshlrev_b32 v74, 16, v69
    v_and_b32 v75, s47, v69
    v_pk_mul_f32 v[72:73], v[72:73], v[64:65] op_sel:[0,0] op_sel_hi:[1,0]
    v_pk_mul_f32 v[74:75], v[74:75], v[64:65] op_sel:[0,0] op_sel_hi:[1,0]
    s_waitcnt vmcnt(4)
    v_lshlrev_b32 v96, 16, v78
    v_and_b32 v97, s47, v78
    v_lshlrev_b32 v98, 16, v79
    v_and_b32 v99, s47, v79
    v_pk_mul_f32 v[96:97], v[96:97], v[64:65] op_sel:[0,0] op_sel_hi:[1,0]
    v_pk_mul_f32 v[98:99], v[98:99], v[64:65] op_sel:[0,0] op_sel_hi:[1,0]
    s_waitcnt vmcnt(2)
    v_lshlrev_b32 v120, 16, v92
    v_and_b32 v121, s47, v92
    v_lshlrev_b32 v122, 16, v93
    v_and_b32 v123, s47, v93
    v_pk_mul_f32 v[120:121], v[120:121], v[64:65] op_sel:[0,0] op_sel_hi:[1,0]
    v_pk_mul_f32 v[122:123], v[122:123], v[64:65] op_sel:[0,0] op_sel_hi:[1,0]
    s_waitcnt vmcnt(1)
    v_lshlrev_b32 v144, 16, v102
    v_and_b32 v145, s47, v102
    v_lshlrev_b32 v146, 16, v103
    v_and_b32 v147, s47, v103
    v_pk_mul_f32 v[144:145], v[144:145], v[64:65] op_sel:[0,0] op_sel_hi:[1,0]
    v_pk_mul_f32 v[146:147], v[146:147], v[64:65] op_sel:[0,0] op_sel_hi:[1,0]
    s_waitcnt lgkmcnt(2)
    v_pk_fma_f32 v[144:145], v[236:237], v[156:157], v[144:145] op_sel:[0,0,0] op_sel_hi:[1,0,1]
    v_pk_fma_f32 v[146:147], v[238:239], v[156:157], v[146:147] op_sel:[0,0,0] op_sel_hi:[1,0,1]
    v_pk_fma_f32 v[16:17], v[16:17], v[156:157], v[72:73] op_sel:[0,0,0] op_sel_hi:[1,0,1]
    v_pk_fma_f32 v[18:19], v[18:19], v[156:157], v[74:75] op_sel:[0,0,0] op_sel_hi:[1,0,1]
    v_cvt_pk_bf16_f32 v16, v16, v17
    v_cvt_pk_bf16_f32 v17, v18, v19
    ds_write_b64 v140, v[16:17] offset:0
    v_pk_fma_f32 v[28:29], v[28:29], v[156:157], v[96:97] op_sel:[0,0,0] op_sel_hi:[1,0,1]
    v_pk_fma_f32 v[30:31], v[30:31], v[156:157], v[98:99] op_sel:[0,0,0] op_sel_hi:[1,0,1]
    v_cvt_pk_bf16_f32 v28, v28, v29
    v_cvt_pk_bf16_f32 v29, v30, v31
    ds_write_b64 v141, v[28:29] offset:0
    v_pk_fma_f32 v[40:41], v[40:41], v[156:157], v[120:121] op_sel:[0,0,0] op_sel_hi:[1,0,1]
    v_pk_fma_f32 v[42:43], v[42:43], v[156:157], v[122:123] op_sel:[0,0,0] op_sel_hi:[1,0,1]
    v_cvt_pk_bf16_f32 v40, v40, v41
    v_cvt_pk_bf16_f32 v41, v42, v43
    ds_write_b64 v142, v[40:41] offset:0
    v_pk_fma_f32 v[52:53], v[52:53], v[156:157], v[144:145] op_sel:[0,0,0] op_sel_hi:[1,0,1]
    v_pk_fma_f32 v[54:55], v[54:55], v[156:157], v[146:147] op_sel:[0,0,0] op_sel_hi:[1,0,1]
    v_cvt_pk_bf16_f32 v52, v52, v53
    v_cvt_pk_bf16_f32 v53, v54, v55
    ds_write_b64 v143, v[52:53] offset:0
    v_lshlrev_b32 v80, 16, v70
    v_and_b32 v81, s47, v70
    v_lshlrev_b32 v82, 16, v71
    v_and_b32 v83, s47, v71
    v_pk_mul_f32 v[80:81], v[80:81], v[64:65] op_sel:[0,1] op_sel_hi:[1,1]
    v_pk_mul_f32 v[82:83], v[82:83], v[64:65] op_sel:[0,1] op_sel_hi:[1,1]
    v_lshlrev_b32 v104, 16, v84
    v_and_b32 v105, s47, v84
    v_lshlrev_b32 v106, 16, v85
    v_and_b32 v107, s47, v85
    v_pk_mul_f32 v[104:105], v[104:105], v[64:65] op_sel:[0,1] op_sel_hi:[1,1]
    v_pk_mul_f32 v[106:107], v[106:107], v[64:65] op_sel:[0,1] op_sel_hi:[1,1]
    v_lshlrev_b32 v128, 16, v94
    v_and_b32 v129, s47, v94
    v_lshlrev_b32 v130, 16, v95
    v_and_b32 v131, s47, v95
    v_pk_mul_f32 v[128:129], v[128:129], v[64:65] op_sel:[0,1] op_sel_hi:[1,1]
    v_pk_mul_f32 v[130:131], v[130:131], v[64:65] op_sel:[0,1] op_sel_hi:[1,1]
    s_waitcnt vmcnt(0)
    v_lshlrev_b32 v152, 16, v108
    v_and_b32 v153, s47, v108
    v_lshlrev_b32 v154, 16, v109
    v_and_b32 v155, s47, v109
    v_pk_mul_f32 v[152:153], v[152:153], v[64:65] op_sel:[0,1] op_sel_hi:[1,1]
    v_pk_mul_f32 v[154:155], v[154:155], v[64:65] op_sel:[0,1] op_sel_hi:[1,1]
    s_waitcnt lgkmcnt(5)
    v_pk_fma_f32 v[152:153], v[244:245], v[156:157], v[152:153] op_sel:[0,1,0] op_sel_hi:[1,1,1]
    v_pk_fma_f32 v[154:155], v[246:247], v[156:157], v[154:155] op_sel:[0,1,0] op_sel_hi:[1,1,1]
    s_waitcnt lgkmcnt(0)
    ds_read_b128 v[164:167], v148 offset:0
    ds_read_b128 v[172:175], v148 offset:1024
    v_pk_fma_f32 v[20:21], v[20:21], v[156:157], v[80:81] op_sel:[0,1,0] op_sel_hi:[1,1,1]
    v_pk_fma_f32 v[22:23], v[22:23], v[156:157], v[82:83] op_sel:[0,1,0] op_sel_hi:[1,1,1]
    v_cvt_pk_bf16_f32 v20, v20, v21
    v_cvt_pk_bf16_f32 v21, v22, v23
    ds_write_b64 v140, v[20:21] offset:2048
    v_pk_fma_f32 v[32:33], v[32:33], v[156:157], v[104:105] op_sel:[0,1,0] op_sel_hi:[1,1,1]
    v_pk_fma_f32 v[34:35], v[34:35], v[156:157], v[106:107] op_sel:[0,1,0] op_sel_hi:[1,1,1]
    v_cvt_pk_bf16_f32 v32, v32, v33
    v_cvt_pk_bf16_f32 v33, v34, v35
    ds_write_b64 v141, v[32:33] offset:2048
    v_pk_fma_f32 v[44:45], v[44:45], v[156:157], v[128:129] op_sel:[0,1,0] op_sel_hi:[1,1,1]
    v_pk_fma_f32 v[46:47], v[46:47], v[156:157], v[130:131] op_sel:[0,1,0] op_sel_hi:[1,1,1]
    v_cvt_pk_bf16_f32 v44, v44, v45
    v_cvt_pk_bf16_f32 v45, v46, v47
    ds_write_b64 v142, v[44:45] offset:2048
    v_pk_fma_f32 v[56:57], v[56:57], v[156:157], v[152:153] op_sel:[0,1,0] op_sel_hi:[1,1,1]
    v_pk_fma_f32 v[58:59], v[58:59], v[156:157], v[154:155] op_sel:[0,1,0] op_sel_hi:[1,1,1]
    v_cvt_pk_bf16_f32 v56, v56, v57
    v_cvt_pk_bf16_f32 v57, v58, v59
    ds_write_b64 v143, v[56:57] offset:2048
    s_add_u32 s37, s45, 0
    s_waitcnt lgkmcnt(5)
    buffer_store_dwordx4 v[164:167], v135, s[24:27], s37 offen
    s_add_u32 s37, s45, 4096
    s_waitcnt lgkmcnt(4)
    buffer_store_dwordx4 v[172:175], v135, s[24:27], s37 offen
    v_lshlrev_b32 v88, 16, v76
    v_and_b32 v89, s47, v76
    v_lshlrev_b32 v90, 16, v77
    v_and_b32 v91, s47, v77
    v_pk_mul_f32 v[88:89], v[88:89], v[66:67] op_sel:[0,0] op_sel_hi:[1,0]
    v_pk_mul_f32 v[90:91], v[90:91], v[66:67] op_sel:[0,0] op_sel_hi:[1,0]
    v_lshlrev_b32 v112, 16, v86
    v_and_b32 v113, s47, v86
    v_lshlrev_b32 v114, 16, v87
    v_and_b32 v115, s47, v87
    v_pk_mul_f32 v[112:113], v[112:113], v[66:67] op_sel:[0,0] op_sel_hi:[1,0]
    v_pk_mul_f32 v[114:115], v[114:115], v[66:67] op_sel:[0,0] op_sel_hi:[1,0]
    v_lshlrev_b32 v136, 16, v100
    v_and_b32 v137, s47, v100
    v_lshlrev_b32 v138, 16, v101
    v_and_b32 v139, s47, v101
    v_pk_mul_f32 v[136:137], v[136:137], v[66:67] op_sel:[0,0] op_sel_hi:[1,0]
    v_pk_mul_f32 v[138:139], v[138:139], v[66:67] op_sel:[0,0] op_sel_hi:[1,0]
    v_lshlrev_b32 v160, 16, v110
    v_and_b32 v161, s47, v110
    v_lshlrev_b32 v162, 16, v111
    v_and_b32 v163, s47, v111
    v_pk_mul_f32 v[160:161], v[160:161], v[66:67] op_sel:[0,0] op_sel_hi:[1,0]
    v_pk_mul_f32 v[162:163], v[162:163], v[66:67] op_sel:[0,0] op_sel_hi:[1,0]
    v_pk_fma_f32 v[136:137], v[228:229], v[158:159], v[136:137] op_sel:[0,0,0] op_sel_hi:[1,0,1]
    v_pk_fma_f32 v[138:139], v[230:231], v[158:159], v[138:139] op_sel:[0,0,0] op_sel_hi:[1,0,1]
    v_pk_fma_f32 v[160:161], v[252:253], v[158:159], v[160:161] op_sel:[0,0,0] op_sel_hi:[1,0,1]
    v_pk_fma_f32 v[162:163], v[254:255], v[158:159], v[162:163] op_sel:[0,0,0] op_sel_hi:[1,0,1]
    s_waitcnt lgkmcnt(0)
    ds_read_b128 v[180:183], v148 offset:2048
    ds_read_b128 v[188:191], v148 offset:3072
    v_pk_fma_f32 v[24:25], v[24:25], v[158:159], v[88:89] op_sel:[0,0,0] op_sel_hi:[1,0,1]
    v_pk_fma_f32 v[26:27], v[26:27], v[158:159], v[90:91] op_sel:[0,0,0] op_sel_hi:[1,0,1]
    v_cvt_pk_bf16_f32 v24, v24, v25
    v_cvt_pk_bf16_f32 v25, v26, v27
    ds_write_b64 v140, v[24:25] offset:4096
    v_pk_fma_f32 v[36:37], v[36:37], v[158:159], v[112:113] op_sel:[0,0,0] op_sel_hi:[1,0,1]
    v_pk_fma_f32 v[38:39], v[38:39], v[158:159], v[114:115] op_sel:[0,0,0] op_sel_hi:[1,0,1]
    v_cvt_pk_bf16_f32 v36, v36, v37
    v_cvt_pk_bf16_f32 v37, v38, v39
    ds_write_b64 v141, v[36:37] offset:4096
    v_pk_fma_f32 v[48:49], v[48:49], v[158:159], v[136:137] op_sel:[0,0,0] op_sel_hi:[1,0,1]
    v_pk_fma_f32 v[50:51], v[50:51], v[158:159], v[138:139] op_sel:[0,0,0] op_sel_hi:[1,0,1]
    v_cvt_pk_bf16_f32 v48, v48, v49
    v_cvt_pk_bf16_f32 v49, v50, v51
    ds_write_b64 v142, v[48:49] offset:4096
    v_pk_fma_f32 v[60:61], v[60:61], v[158:159], v[160:161] op_sel:[0,0,0] op_sel_hi:[1,0,1]
    v_pk_fma_f32 v[62:63], v[62:63], v[158:159], v[162:163] op_sel:[0,0,0] op_sel_hi:[1,0,1]
    v_cvt_pk_bf16_f32 v60, v60, v61
    v_cvt_pk_bf16_f32 v61, v62, v63
    ds_write_b64 v143, v[60:61] offset:4096
    s_add_u32 s37, s45, 8192
    s_waitcnt lgkmcnt(5)
    buffer_store_dwordx4 v[180:183], v135, s[24:27], s37 offen
    s_add_u32 s37, s45, 12288
    s_waitcnt lgkmcnt(4)
    buffer_store_dwordx4 v[188:191], v135, s[24:27], s37 offen
    s_waitcnt lgkmcnt(0)
    ds_read_b128 v[196:199], v148 offset:4096
    ds_read_b128 v[204:207], v148 offset:5120
    s_add_u32 s37, s45, 16384
    s_waitcnt lgkmcnt(1)
    buffer_store_dwordx4 v[196:199], v135, s[24:27], s37 offen
    s_add_u32 s37, s45, 20480
    s_waitcnt lgkmcnt(0)
    buffer_store_dwordx4 v[204:207], v135, s[24:27], s37 offen
L_end:
    s_endpgm
L_ack_spin:
    s_mov_b32 s46, 131072
L_ack_loop:
    buffer_load_dwordx2 v[34:35], off, s[28:31], s41 offset:8 sc1
    s_waitcnt vmcnt(0)
    v_readfirstlane_b32 s47, v34
    s_sub_u32 s46, s46, 1
    s_nop 0
    s_cmp_eq_u32 s47, s43
    s_cbranch_scc1 L_ack_ok
    s_cmp_lg_u32 s46, 0
    s_cbranch_scc1 L_ack_loop
    s_branch L_ack_ok
L_poll_spin:
    s_mov_b32 s46, 131072
L_poll_loop:
    buffer_load_dword v126, off, s[28:31], s41 offset:0 sc1
    s_waitcnt vmcnt(0)
    v_readfirstlane_b32 s47, v126
    s_sub_u32 s46, s46, 1
    s_nop 0
    s_cmp_eq_u32 s47, s42
    s_cbranch_scc1 L_poll_ok
    s_cmp_lg_u32 s46, 0
    s_cbranch_scc1 L_poll_loop
    s_branch L_poll_ok
L_exact:
    s_waitcnt vmcnt(0) lgkmcnt(0)
    s_barrier
    s_mov_b32 s82, 1
    v_accvgpr_read_b32 v16, a164
    v_accvgpr_read_b32 v17, a165
    v_accvgpr_read_b32 v18, a166
    v_accvgpr_read_b32 v19, a167
    v_accvgpr_read_b32 v20, a168
    v_accvgpr_read_b32 v21, a169
    v_accvgpr_read_b32 v22, a170
    v_accvgpr_read_b32 v23, a171
    v_xor_b32 v7, 2048, v15
    v_add_u32 v24, s80, v20
    v_add_u32 v25, s80, v21
    v_add_u32 v26, s80, v22
    v_add_u32 v27, s80, v23
    v_add_u32 v44, s81, v8
    v_add_u32 v45, s81, v9
    v_add_u32 v46, s81, v10
    v_add_u32 v47, s81, v11
    s_add_u32 m0, s84, 0
    s_add_u32 s37, s85, 0
    buffer_load_dwordx4 v16, s[12:15], s37 offen offset:0 nt lds
    buffer_load_dwordx4 v17, s[12:15], s37 offen offset:1024 nt lds
    buffer_load_dwordx4 v18, s[12:15], s37 offen offset:2048 nt lds
    buffer_load_dwordx4 v19, s[12:15], s37 offen offset:3072 nt lds
    s_add_u32 m0, s84, 8192
    s_add_u32 s37, s85, 8192
    buffer_load_dwordx4 v16, s[12:15], s37 offen offset:0 nt lds
    buffer_load_dwordx4 v17, s[12:15], s37 offen offset:1024 nt lds
    buffer_load_dwordx4 v18, s[12:15], s37 offen offset:2048 nt lds
    buffer_load_dwordx4 v19, s[12:15], s37 offen offset:3072 nt lds
    s_add_u32 m0, s84, 16384
    s_add_u32 s37, s85, 16384
    buffer_load_dwordx4 v16, s[12:15], s37 offen offset:0 nt lds
    buffer_load_dwordx4 v17, s[12:15], s37 offen offset:1024 nt lds
    buffer_load_dwordx4 v18, s[12:15], s37 offen offset:2048 nt lds
    buffer_load_dwordx4 v19, s[12:15], s37 offen offset:3072 nt lds
    s_waitcnt vmcnt(0)
    s_barrier
    ds_read_b128 a[0:3], v24 offset:0
    ds_read_b128 a[4:7], v25 offset:0
    ds_read_b128 a[8:11], v26 offset:0
    ds_read_b128 a[12:15], v27 offset:0
    ds_read_b128 a[16:19], v24 offset:256
    ds_read_b128 a[20:23], v25 offset:256
    ds_read_b128 a[24:27], v26 offset:256
    ds_read_b128 a[28:31], v27 offset:256
    s_waitcnt lgkmcnt(0)
    ds_read_b128 a[32:35], v24 offset:8192
    ds_read_b128 a[36:39], v25 offset:8192
    ds_read_b128 a[40:43], v26 offset:8192
    ds_read_b128 a[44:47], v27 offset:8192
    ds_read_b128 a[48:51], v24 offset:8448
    ds_read_b128 a[52:55], v25 offset:8448
    ds_read_b128 a[56:59], v26 offset:8448
    ds_read_b128 a[60:63], v27 offset:8448
    s_waitcnt lgkmcnt(0)
    ds_read_b128 a[64:67], v24 offset:16384
    ds_read_b128 a[68:71], v25 offset:16384
    ds_read_b128 a[72:75], v26 offset:16384
    ds_read_b128 a[76:79], v27 offset:16384
    ds_read_b128 a[80:83], v24 offset:16640
    ds_read_b128 a[84:87], v25 offset:16640
    ds_read_b128 a[88:91], v26 offset:16640
    ds_read_b128 a[92:95], v27 offset:16640
    s_waitcnt lgkmcnt(0)
    v_mov_b32 v2, 0xff800000
    v_mov_b32 v3, 0xff800000
    v_mov_b32 v4, 0xff800000
    s_mov_b32 s46, 0
L_exact_loop:
    s_barrier
    s_mov_b32 m0, s33
    s_add_u32 s37, s34, s46
    buffer_load_dwordx4 v16, s[16:19], s37 offen offset:0 nt lds
    buffer_load_dwordx4 v17, s[16:19], s37 offen offset:1024 nt lds
    buffer_load_dwordx4 v18, s[16:19], s37 offen offset:2048 nt lds
    buffer_load_dwordx4 v19, s[16:19], s37 offen offset:3072 nt lds
    s_waitcnt vmcnt(0)
    s_barrier
    ds_read_b128 a[96:99], v20 offset:0
    ds_read_b128 a[100:103], v21 offset:0
    ds_read_b128 a[104:107], v22 offset:0
    ds_read_b128 a[108:111], v23 offset:0
    ds_read_b128 a[112:115], v20 offset:256
    ds_read_b128 a[116:119], v21 offset:256
    ds_read_b128 a[120:123], v22 offset:256
    ds_read_b128 a[124:127], v23 offset:256
    s_waitcnt lgkmcnt(0)
    v_mfma_f32_16x16x32_bf16 v[64:67], a[96:99], a[0:3], 0
    v_mfma_f32_16x16x32_bf16 v[64:67], a[100:103], a[4:7], v[64:67]
    v_mfma_f32_16x16x32_bf16 v[64:67], a[104:107], a[8:11], v[64:67]
    v_mfma_f32_16x16x32_bf16 v[64:67], a[108:111], a[12:15], v[64:67]
    v_mfma_f32_16x16x32_bf16 v[64:67], a[112:115], a[16:19], v[64:67]
    v_mfma_f32_16x16x32_bf16 v[64:67], a[116:119], a[20:23], v[64:67]
    v_mfma_f32_16x16x32_bf16 v[64:67], a[120:123], a[24:27], v[64:67]
    v_mfma_f32_16x16x32_bf16 v[64:67], a[124:127], a[28:31], v[64:67]
    v_mfma_f32_16x16x32_bf16 v[72:75], a[96:99], a[32:35], 0
    v_mfma_f32_16x16x32_bf16 v[72:75], a[100:103], a[36:39], v[72:75]
    v_mfma_f32_16x16x32_bf16 v[72:75], a[104:107], a[40:43], v[72:75]
    v_mfma_f32_16x16x32_bf16 v[72:75], a[108:111], a[44:47], v[72:75]
    v_mfma_f32_16x16x32_bf16 v[72:75], a[112:115], a[48:51], v[72:75]
    v_mfma_f32_16x16x32_bf16 v[72:75], a[116:119], a[52:55], v[72:75]
    v_mfma_f32_16x16x32_bf16 v[72:75], a[120:123], a[56:59], v[72:75]
    v_mfma_f32_16x16x32_bf16 v[72:75], a[124:127], a[60:63], v[72:75]
    v_mfma_f32_16x16x32_bf16 v[80:83], a[96:99], a[64:67], 0
    v_mfma_f32_16x16x32_bf16 v[80:83], a[100:103], a[68:71], v[80:83]
    v_mfma_f32_16x16x32_bf16 v[80:83], a[104:107], a[72:75], v[80:83]
    v_mfma_f32_16x16x32_bf16 v[80:83], a[108:111], a[76:79], v[80:83]
    v_mfma_f32_16x16x32_bf16 v[80:83], a[112:115], a[80:83], v[80:83]
    v_mfma_f32_16x16x32_bf16 v[80:83], a[116:119], a[84:87], v[80:83]
    v_mfma_f32_16x16x32_bf16 v[80:83], a[120:123], a[88:91], v[80:83]
    v_mfma_f32_16x16x32_bf16 v[80:83], a[124:127], a[92:95], v[80:83]
    s_nop 7
    v_max3_f32 v2, v2, v64, v65
    v_max3_f32 v3, v3, v72, v73
    v_max3_f32 v4, v4, v80, v81
    v_max3_f32 v2, v2, v66, v67
    v_max3_f32 v3, v3, v74, v75
    v_max3_f32 v4, v4, v82, v83
    s_add_u32 s46, s46, 4096
    s_cmp_lt_u32 s46, 65536
    s_cbranch_scc1 L_exact_loop
    v_mov_b32 v36, v2
    v_mov_b32 v37, v3
    v_mov_b32 v38, v4
    v_permlane32_swap_b32 v2, v36
    v_permlane32_swap_b32 v3, v37
    v_permlane32_swap_b32 v4, v38
    v_max_f32 v2, v2, v36
    v_max_f32 v3, v3, v37
    v_max_f32 v4, v4, v38
    v_mov_b32 v36, v2
    v_mov_b32 v37, v3
    v_mov_b32 v38, v4
    v_permlane16_swap_b32 v2, v36
    v_permlane16_swap_b32 v3, v37
    v_permlane16_swap_b32 v4, v38
    v_max_f32 v2, v2, v36
    v_max_f32 v3, v3, v37
    v_max_f32 v4, v4, v38
    ds_write_b128 v7, v[2:5]
    s_waitcnt lgkmcnt(0)
    s_barrier
    ds_read_b128 v[36:39], v15
    s_waitcnt lgkmcnt(0)
    v_max_f32 v2, v2, v36
    v_max_f32 v3, v3, v37
    v_max_f32 v4, v4, v38
    v_mul_f32 v2, s38, v2
    v_mul_f32 v3, s38, v3
    v_mul_f32 v4, s38, v4
    v_ceil_f32 v2, v2
    v_ceil_f32 v3, v3
    v_ceil_f32 v4, v4
    v_accvgpr_write_b32 a172, v2
    v_accvgpr_write_b32 a173, v3
    v_accvgpr_write_b32 a174, v4
    s_barrier
    s_add_u32 s4, s34, 0
    s_add_u32 m0, s33, 0
    s_nop 0
    buffer_load_dwordx4 v16, s[16:19], s4 offen offset:0 nt lds
    buffer_load_dwordx4 v17, s[16:19], s4 offen offset:1024 nt lds
    buffer_load_dwordx4 v18, s[16:19], s4 offen offset:2048 nt lds
    buffer_load_dwordx4 v19, s[16:19], s4 offen offset:3072 nt lds
    s_add_u32 s8, s34, 4096
    s_add_u32 m0, s33, 8192
    s_nop 0
    buffer_load_dwordx4 v16, s[16:19], s8 offen offset:0 nt lds
    buffer_load_dwordx4 v17, s[16:19], s8 offen offset:1024 nt lds
    buffer_load_dwordx4 v18, s[16:19], s8 offen offset:2048 nt lds
    buffer_load_dwordx4 v19, s[16:19], s8 offen offset:3072 nt lds
    s_add_u32 s4, s34, 8192
    s_add_u32 m0, s33, 16384
    s_nop 0
    buffer_load_dwordx4 v16, s[16:19], s4 offen offset:0 nt lds
    buffer_load_dwordx4 v17, s[16:19], s4 offen offset:1024 nt lds
    buffer_load_dwordx4 v18, s[16:19], s4 offen offset:2048 nt lds
    buffer_load_dwordx4 v19, s[16:19], s4 offen offset:3072 nt lds
    s_waitcnt vmcnt(0)
    s_branch L_main
L_send_far:
    s_waitcnt lgkmcnt(6)
    v_mfma_f32_16x16x32_bf16 a[48:51], a[192:195], v[64:67], 0
    ds_read_b64_tr_b16 a[208:209], v8 offset:36864
    v_mfma_f32_16x16x32_bf16 a[52:55], a[192:195], v[72:75], 0
    ds_read_b64_tr_b16 a[210:211], v8 offset:38912
    v_mfma_f32_16x16x32_bf16 a[56:59], a[192:195], v[80:83], 0
    s_waitcnt lgkmcnt(6)
    ds_read_b64_tr_b16 a[212:213], v9 offset:36864
    v_cvt_pk_bf16_f32 v16, v16, v17
    v_cvt_pk_bf16_f32 v17, v18, v19
    v_cvt_pk_bf16_f32 v18, v20, v21
    v_mfma_f32_16x16x32_bf16 a[60:63], a[196:199], v[64:67], 0
    ds_read_b64_tr_b16 a[214:215], v9 offset:38912
    v_cvt_pk_bf16_f32 v19, v22, v23
    v_cvt_pk_bf16_f32 v24, v24, v25
    v_mfma_f32_16x16x32_bf16 a[64:67], a[196:199], v[72:75], 0
    s_add_u32 s37, s44, 0
    buffer_store_dwordx4 v[16:19], v5, s[24:27], s37 offen sc1
    ds_read_b64_tr_b16 a[216:217], v10 offset:36864
    v_mfma_f32_16x16x32_bf16 a[68:71], a[196:199], v[80:83], 0
    s_waitcnt lgkmcnt(7)
    ds_read_b64_tr_b16 a[218:219], v10 offset:38912
    v_cvt_pk_bf16_f32 v25, v26, v27
    v_cvt_pk_bf16_f32 v26, v28, v29
    v_cvt_pk_bf16_f32 v27, v30, v31
    v_mfma_f32_16x16x32_bf16 a[72:75], a[200:203], v[64:67], 0
    s_add_u32 s37, s44, 4096
    buffer_store_dwordx4 v[24:27], v5, s[24:27], s37 offen sc1
    ds_read_b64_tr_b16 a[220:221], v11 offset:36864
    v_mfma_f32_16x16x32_bf16 a[76:79], a[200:203], v[72:75], 0
    ds_read_b64_tr_b16 a[222:223], v11 offset:38912
    v_cvt_pk_bf16_f32 v32, v32, v33
    v_cvt_pk_bf16_f32 v33, v34, v35
    v_mfma_f32_16x16x32_bf16 a[80:83], a[200:203], v[80:83], 0
    s_waitcnt lgkmcnt(8)
    v_cvt_pk_bf16_f32 v34, v36, v37
    v_cvt_pk_bf16_f32 v35, v38, v39
    v_cvt_pk_bf16_f32 v40, v40, v41
    v_cvt_pk_bf16_f32 v41, v42, v43
    v_mfma_f32_16x16x32_bf16 a[84:87], a[204:207], v[64:67], 0
    s_add_u32 s37, s44, 8192
    buffer_store_dwordx4 v[32:35], v5, s[24:27], s37 offen sc1
    v_cvt_pk_bf16_f32 v42, v44, v45
    v_mfma_f32_16x16x32_bf16 a[88:91], a[204:207], v[72:75], 0
    v_cvt_pk_bf16_f32 v43, v46, v47
    v_cvt_pk_bf16_f32 v48, v48, v49
    v_cvt_pk_bf16_f32 v49, v50, v51
    v_mfma_f32_16x16x32_bf16 a[92:95], a[204:207], v[80:83], 0
    s_add_u32 s37, s44, 12288
    buffer_store_dwordx4 v[40:43], v5, s[24:27], s37 offen sc1
    v_cvt_pk_bf16_f32 v50, v52, v53
    s_waitcnt lgkmcnt(6)
    v_mfma_f32_16x16x32_bf16 a[48:51], a[208:211], v[88:91], a[48:51]
    v_cvt_pk_bf16_f32 v51, v54, v55
    v_cvt_pk_bf16_f32 v56, v56, v57
    v_cvt_pk_bf16_f32 v57, v58, v59
    v_cvt_pk_bf16_f32 v58, v60, v61
    v_mfma_f32_16x16x32_bf16 a[52:55], a[208:211], v[96:99], a[52:55]
    s_add_u32 s37, s44, 16384
    buffer_store_dwordx4 v[48:51], v5, s[24:27], s37 offen sc1
    v_cvt_pk_bf16_f32 v59, v62, v63
    v_mfma_f32_16x16x32_bf16 a[56:59], a[208:211], v[104:107], a[56:59]
    s_waitcnt lgkmcnt(4)
    s_add_u32 s37, s44, 20480
    buffer_store_dwordx4 v[56:59], v5, s[24:27], s37 offen sc1
    v_mov_b32 v20, v2
    v_mov_b32 v21, v12
    v_mfma_f32_16x16x32_bf16 a[60:63], a[212:215], v[88:91], a[60:63]
    v_mov_b32 v22, v3
    v_mov_b32 v23, v13
    v_mov_b32 v28, v4
    v_mfma_f32_16x16x32_bf16 a[64:67], a[212:215], v[96:99], a[64:67]
    v_mov_b32 v29, v14
    v_lshlrev_b32 v31, 4, v7
    v_lshlrev_b32 v30, 3, v7
    v_mfma_f32_16x16x32_bf16 a[68:71], a[212:215], v[104:107], a[68:71]
    s_mov_b64 exec, 0xffff
    buffer_store_dwordx4 v[20:23], v31, s[28:31], s40 offen offset:128 sc1
    buffer_store_dwordx2 v[28:29], v30, s[28:31], s40 offen offset:384 sc1
    s_mov_b64 exec, -1
    s_branch L_send_join
L_flag_far:
    buffer_store_dword v159, off, s[28:31], s40 sc1
    s_branch L_flag_join
L_pollq_far:
    buffer_load_dword v126, off, s[28:31], s41 sc1
    s_branch L_pollq_join
L_recv_far:
    v_mfma_f32_16x16x32_bf16 v[40:43], a[216:219], v[88:91], v[40:43]
    ds_read_b64_tr_b16 a[224:225], v8 offset:24576
    ds_read_b64_tr_b16 a[226:227], v8 offset:26624
    v_mfma_f32_16x16x32_bf16 v[44:47], a[216:219], v[96:99], v[44:47]
    ds_read_b64_tr_b16 a[228:229], v9 offset:24576
    ds_read_b64_tr_b16 a[230:231], v9 offset:26624
    v_mfma_f32_16x16x32_bf16 v[48:51], a[216:219], v[104:107], v[48:51]
    ds_read_b64_tr_b16 a[232:233], v10 offset:24576
    ds_read_b64_tr_b16 a[234:235], v10 offset:26624
    v_mfma_f32_16x16x32_bf16 v[52:55], a[220:223], v[88:91], v[52:55]
    ds_read_b64_tr_b16 a[236:237], v11 offset:24576
    ds_read_b64_tr_b16 a[238:239], v11 offset:26624
    v_mfma_f32_16x16x32_bf16 v[56:59], a[220:223], v[96:99], v[56:59]
    ds_read_b64_tr_b16 a[240:241], v8 offset:28672
    ds_read_b64_tr_b16 a[242:243], v8 offset:30720
    v_mfma_f32_16x16x32_bf16 v[60:63], a[220:223], v[104:107], v[60:63]
    s_waitcnt lgkmcnt(8)
    ds_read_b64_tr_b16 a[244:245], v9 offset:28672
    ds_read_b64_tr_b16 a[246:247], v9 offset:30720
    v_mfma_f32_16x16x32_bf16 v[16:19], a[224:227], v[112:115], v[16:19]
    ds_read_b64_tr_b16 a[248:249], v10 offset:28672
    ds_read_b64_tr_b16 a[250:251], v10 offset:30720
    v_mfma_f32_16x16x32_bf16 v[20:23], a[224:227], v[120:123], v[20:23]
    ds_read_b64_tr_b16 a[252:253], v11 offset:28672
    ds_read_b64_tr_b16 a[254:255], v11 offset:30720
    v_mfma_f32_16x16x32_bf16 v[24:27], a[224:227], v[128:131], v[24:27]
    s_waitcnt lgkmcnt(12)
    ds_read_b128 v[164:167], v1 offset:0
    ds_read_b128 v[172:175], v1 offset:1024
    buffer_load_dwordx4 v[116:119], v133, s[28:31], s41 offen offset:128 sc1
    v_mfma_f32_16x16x32_bf16 v[28:31], a[228:231], v[112:115], v[28:31]
    ds_read_b128 v[180:183], v1 offset:2048
    s_waitcnt lgkmcnt(11)
    ds_read_b128 v[188:191], v1 offset:3072
    buffer_load_dwordx2 v[124:125], v134, s[28:31], s41 offen offset:384 sc1
    s_add_u32 s88, s45, 0
    v_mfma_f32_16x16x32_bf16 v[32:35], a[228:231], v[120:123], v[32:35]
    buffer_load_dwordx4 v[68:71], v5, s[24:27], s88 offen sc1
    v_mfma_f32_16x16x32_bf16 v[36:39], a[228:231], v[128:131], v[36:39]
    s_add_u32 s89, s45, 4096
    ds_write_b128 v0, a[64:67] offset:4096
    v_mfma_f32_16x16x32_bf16 v[40:43], a[232:235], v[112:115], v[40:43]
    buffer_load_dwordx4 v[76:79], v5, s[24:27], s89 offen sc1
    s_add_u32 s90, s45, 8192
    v_mfma_f32_16x16x32_bf16 v[44:47], a[232:235], v[120:123], v[44:47]
    buffer_load_dwordx4 v[84:87], v5, s[24:27], s90 offen sc1
    v_mfma_f32_16x16x32_bf16 v[48:51], a[232:235], v[128:131], v[48:51]
    s_add_u32 s91, s45, 12288
    ds_write_b128 v0, a[68:71] offset:5120
    v_mfma_f32_16x16x32_bf16 v[52:55], a[236:239], v[112:115], v[52:55]
    buffer_load_dwordx4 v[92:95], v5, s[24:27], s91 offen sc1
    s_add_u32 s88, s45, 16384
    v_mfma_f32_16x16x32_bf16 v[56:59], a[236:239], v[120:123], v[56:59]
    buffer_load_dwordx4 v[100:103], v5, s[24:27], s88 offen sc1
    v_mfma_f32_16x16x32_bf16 v[60:63], a[236:239], v[128:131], v[60:63]
    s_waitcnt lgkmcnt(12)
    s_add_u32 s89, s45, 20480
    ds_write_b128 v0, a[72:75] offset:6144
    v_mfma_f32_16x16x32_bf16 v[16:19], a[240:243], v[136:139], v[16:19]
    buffer_load_dwordx4 v[108:111], v5, s[24:27], s89 offen sc1
    v_mfma_f32_16x16x32_bf16 v[20:23], a[240:243], v[144:147], v[20:23]
    v_mfma_f32_16x16x32_bf16 v[24:27], a[240:243], v[152:155], v[24:27]
    s_waitcnt lgkmcnt(11)
    ds_write_b128 v0, a[76:79] offset:7168
    v_mfma_f32_16x16x32_bf16 v[28:31], a[244:247], v[136:139], v[28:31]
    v_mfma_f32_16x16x32_bf16 v[32:35], a[244:247], v[144:147], v[32:35]
    v_mfma_f32_16x16x32_bf16 v[36:39], a[244:247], v[152:155], v[36:39]
    s_branch L_recv_join
L_code_end:
.section .rodata,"a"
.p2align 6
.amdhsa_kernel standalone__gqa_softmax__near_ridge_kernel
.amdhsa_next_free_vgpr 512
.amdhsa_next_free_sgpr 102
.amdhsa_accum_offset 256
.amdhsa_group_segment_fixed_size 0
.amdhsa_kernarg_size 48
.amdhsa_user_sgpr_count 2
.amdhsa_user_sgpr_kernarg_segment_ptr 1
.amdhsa_system_sgpr_workgroup_id_x 1
.end_amdhsa_kernel
```
